```python
import torch

def _softmax(x, axis=-1):
    return torch.softmax(x, dim=axis)
def _gelu(x):
    return torch.nn.functional.gelu(x, approximate="tanh")
def _silu(x):
    return torch.nn.functional.silu(x)
def _sigmoid(x):
    return torch.sigmoid(x)
def _layernorm(x, axis=-1, eps=1e-5):
    m = x.mean(dim=axis, keepdim=True)
    v = x.var(dim=axis, keepdim=True, unbiased=False)
    return (x - m) / torch.sqrt(v + eps)
def _scatter_add(tgt, idx, src, axis=0):
    return tgt.clone().index_add_(axis, idx, src)
def _segment_sum(src, seg, n):
    out = torch.zeros((n,) + src.shape[1:], dtype=src.dtype)
    return out.index_add_(0, seg, src)
def _pad(x, pw):
    flat = tuple(v for pair in reversed(pw) for v in pair)
    return torch.nn.functional.pad(x, flat)

kernel_name = 'gated_mix__sliding_block_cached__glu_gated_swiglu__decode'

def setup_inputs():

    _w = (lambda a: (lambda t: t.to(torch.bfloat16) if t.is_floating_point() else t)(torch.as_tensor(a)))
    def _A_setup():
        B, Sq, D = 8, 1, 640
        Hq, Hkv, Sk, Dh = 32, 32, 4096, 128
        assert Hq % Hkv == 0, (Hq, Hkv)
        return {
            "x": _w((lambda *s: torch.randn(*s, dtype=torch.bfloat16) * 0.05)(B, Sq, D)),
            "k_cache": _w((lambda *s: torch.randn(*s, dtype=torch.bfloat16) * 6.4)(B, Hkv, Sk, Dh)),
            "v_cache": _w((lambda *s: torch.randn(*s, dtype=torch.bfloat16) * 0.05)(B, Hkv, Sk, Dh)),
            "wq": _w((lambda *s: torch.randn(*s, dtype=torch.bfloat16) * 6.4)(D, Hq * Dh) * (D ** -0.5)),
            "wo": _w((lambda *s: torch.randn(*s, dtype=torch.bfloat16) * 0.05)(Hq * Dh, D) * ((Hq * Dh) ** -0.5)),
        }
    _A_in = _A_setup()

    def _B_setup():
        B, S, D, F = 8, 1, 640, 1728
        return {
            "x": _w((lambda *s: torch.randn(*s, dtype=torch.bfloat16) * 0.05)(B, S, D)),
            "w1": _w((lambda *s: torch.randn(*s, dtype=torch.bfloat16) * 0.4)(D, F) * (2.0 / D) ** 0.5),
            "w3": _w((lambda *s: torch.randn(*s, dtype=torch.bfloat16) * 0.4)(D, F) * (2.0 / D) ** 0.5),
            "w2": _w((lambda *s: torch.randn(*s, dtype=torch.bfloat16) * 0.4)(F, D) * (2.0 / F) ** 0.5),
        }
    _B_in = _B_setup()

    return {
        "A_x": _A_in["x"],
        "A_k_cache": _A_in["k_cache"],
        "A_v_cache": _A_in["v_cache"],
        "A_wq": _A_in["wq"],
        "A_wo": _A_in["wo"],
        "B_x": _B_in["x"],
        "B_w1": _B_in["w1"],
        "B_w3": _B_in["w3"],
        "B_w2": _B_in["w2"],
        "gate_w": _w((lambda *s: torch.randn(*s, dtype=torch.bfloat16) * 0.05)(640) * 16.0),
    }

def reference(A_x, A_k_cache, A_v_cache, A_wq, A_wo, B_x, B_w1, B_w3, B_w2, gate_w):
    def _A_ref(x, k_cache, v_cache, wq, wo):
        B, Sq, D = x.shape
        Hq, Dh = 32, 128
        Hkv, Sk = k_cache.shape[1], k_cache.shape[2]
        W = min(4096, max(256, Sk // 4))
        rep = Hq // Hkv
        q = (lambda x, *d: x.permute(*d))((x @ wq).reshape(B, Sq, Hq, Dh), 0, 2, 1, 3)
        k = (lambda x, n, axis: torch.repeat_interleave(x, n, dim=axis))(k_cache[:, :, Sk - W:, :], rep, axis=1)
        v = (lambda x, n, axis: torch.repeat_interleave(x, n, dim=axis))(v_cache[:, :, Sk - W:, :], rep, axis=1)
        scores = torch.einsum("bhqd,bhkd->bhqk", q, k) * (Dh ** -0.5)
        p = _softmax(scores, axis=-1)
        o = torch.einsum("bhqk,bhkd->bhqd", p, v)
        return (lambda x, *d: x.permute(*d))(o, 0, 2, 1, 3).reshape(B, Sq, Hq * Dh) @ wo

    def _B_ref(x, w1, w3, w2):
        gate = torch.einsum("bsd,df->bsf", x, w1)
        up = torch.einsum("bsd,df->bsf", x, w3)
        h = _silu(gate) * up
        out = torch.einsum("bsf,fd->bsd", h, w2)
        return out

    x = A_x
    g = _sigmoid((x * gate_w).sum(-1, keepdims=True))
    a = _A_ref(x, A_k_cache, A_v_cache, A_wq, A_wo)
    b = _B_ref(x, B_w1, B_w3, B_w2)
    return g * a + (1 - g) * b
```

```asm
; @launch grid=(256,1,1) block=(512,1,1) lds=54272
.amdgcn_target "amdgcn-amd-amdhsa--gfx950"
.text
.globl gated_mix__sliding_block_cached__glu_gated_swiglu__decode_kernel
.p2align 8
.type gated_mix__sliding_block_cached__glu_gated_swiglu__decode_kernel,@function
gated_mix__sliding_block_cached__glu_gated_swiglu__decode_kernel:
s_load_dwordx16 s[4:19], s[0:1], 0
s_load_dwordx8 s[20:27], s[0:1], 64
s_load_dwordx2 s[28:29], s[0:1], 96
s_lshr_b32 s30, s2, 5
v_lshrrev_b32 v1, 6, v0
v_and_b32 v0, 63, v0
s_cmp_ge_u32 s30, 8
s_cbranch_scc1 L_end
v_readfirstlane_b32 s3, v1
s_and_b32 s31, s2, 31
v_lshlrev_b32 v2, 7, v0
s_cmp_ge_u32 s3, 4
s_cbranch_scc1 L_stream
s_lshl_b32 s62, s31, 5
s_lshl2_add_u32 s63, s30, s3
s_add_u32 s62, s62, s63
s_mulk_i32 s62, 2560
v_lshl_add_u32 v3, s62, 1, v2
v_add_u32 v2, s62, v2
s_bfm_b64 exec, 40, 0
s_and_b32 s63, s31, 7
s_cmp_ge_u32 s63, 3
s_waitcnt lgkmcnt(0)
global_load_dword v62, v3, s[12:13]
s_cbranch_scc1 L_nopf
s_bfm_b64 exec, 20, 0
global_load_dword v63, v2, s[20:21]
L_nopf:
s_mov_b64 exec, -1
s_load_dword s56, s[28:29], 0
s_setprio 2
s_cmp_lt_u32 s3, 2
s_cbranch_scc1 L_pa
s_getreg_b32 s62, hwreg(HW_REG_XCC_ID, 0, 4)
s_lshl_b32 s63, s31, 8
s_lshl2_add_u32 s63, s30, s63
s_add_u32 s63, s63, 1572864
v_mov_b32 v2, s63
s_sub_u32 exec_lo, 3, s3
s_mov_b32 exec_hi, 0
s_waitcnt lgkmcnt(0)
s_add_u32 s56, s56, 0x01010101
s_add_u32 s62, s62, s56
s_cbranch_execz L_aux23
v_mov_b32 v3, s62
global_store_dword v2, v3, s[28:29]
s_branch L_aux23
L_pa:
s_and_b32 s58, s30, 3
s_lshr_b32 s59, s30, 2
v_lshrrev_b32 v3, 3, v0
v_and_b32 v9, 7, v0
s_lshl_b32 s62, s31, 8
s_lshl_b32 s63, s59, 7
s_add_u32 s62, s62, s63
s_lshl_b32 s63, s31, 7
s_cmp_eq_u32 s59, 0
s_cselect_b32 s32, s16, s18
s_cselect_b32 s33, s17, s19
s_movk_i32 s61, 3456
s_cmp_eq_u32 s3, 0
s_cselect_b32 s61, 8192, s61
s_cselect_b32 s62, s62, s63
s_cselect_b32 s32, s10, s32
s_cselect_b32 s33, s11, s33
s_mul_i32 s63, s61, s58
s_mulk_i32 s63, 160
s_add_u32 s62, s62, s63
s_add_u32 s32, s32, s62
s_addc_u32 s33, s33, 0
s_mul_i32 s34, s61, 159
s_addk_i32 s34, 128
s_mov_b32 s35, 0x20000
v_mul_u32_u24 v1, s61, v3
v_lshl_add_u32 v1, v9, 4, v1
s_lshl_b32 s61, s61, 3
s_mov_b32 s63, 0
s_mul_i32 s57, s3, s31
s_cmp_ge_u32 s57, 27
s_cbranch_scc1 L_pa_skip
buffer_load_dwordx4 v[64:67], v1, s[32:35], s63 offen nt
s_add_u32 s63, s63, s61
buffer_load_dwordx4 v[68:71], v1, s[32:35], s63 offen nt
s_add_u32 s63, s63, s61
buffer_load_dwordx4 v[72:75], v1, s[32:35], s63 offen nt
s_add_u32 s63, s63, s61
buffer_load_dwordx4 v[76:79], v1, s[32:35], s63 offen nt
s_add_u32 s63, s63, s61
v_mul_u32_u24 v2, 1280, v9
v_lshrrev_b32 v10, 4, v0
v_lshl_add_u32 v2, v10, 4, v2
s_mul_i32 s60, s58, 320
s_mov_b32 s36, s4
s_mov_b32 s37, s5
s_mov_b32 s38, 10240
s_mov_b32 s39, 0x20000
buffer_load_dwordx4 v[224:227], v2, s[36:39], s60 offen offset:0
buffer_load_dwordx4 v[228:231], v2, s[36:39], s60 offen offset:64
buffer_load_dwordx4 v[232:235], v2, s[36:39], s60 offen offset:128
buffer_load_dwordx4 v[236:239], v2, s[36:39], s60 offen offset:192
buffer_load_dwordx4 v[240:243], v2, s[36:39], s60 offen offset:256
buffer_load_dwordx4 v[80:83], v1, s[32:35], s63 offen nt
s_add_u32 s63, s63, s61
buffer_load_dwordx4 v[84:87], v1, s[32:35], s63 offen nt
s_add_u32 s63, s63, s61
buffer_load_dwordx4 v[88:91], v1, s[32:35], s63 offen nt
s_add_u32 s63, s63, s61
buffer_load_dwordx4 v[92:95], v1, s[32:35], s63 offen nt
s_add_u32 s63, s63, s61
buffer_load_dwordx4 v[96:99], v1, s[32:35], s63 offen nt
s_add_u32 s63, s63, s61
buffer_load_dwordx4 v[100:103], v1, s[32:35], s63 offen nt
s_add_u32 s63, s63, s61
buffer_load_dwordx4 v[104:107], v1, s[32:35], s63 offen nt
s_add_u32 s63, s63, s61
buffer_load_dwordx4 v[108:111], v1, s[32:35], s63 offen nt
s_add_u32 s63, s63, s61
buffer_load_dwordx4 v[112:115], v1, s[32:35], s63 offen nt
s_add_u32 s63, s63, s61
buffer_load_dwordx4 v[116:119], v1, s[32:35], s63 offen nt
s_add_u32 s63, s63, s61
buffer_load_dwordx4 v[120:123], v1, s[32:35], s63 offen nt
s_add_u32 s63, s63, s61
buffer_load_dwordx4 v[124:127], v1, s[32:35], s63 offen nt
s_add_u32 s63, s63, s61
buffer_load_dwordx4 v[128:131], v1, s[32:35], s63 offen nt
s_add_u32 s63, s63, s61
buffer_load_dwordx4 v[132:135], v1, s[32:35], s63 offen nt
s_add_u32 s63, s63, s61
buffer_load_dwordx4 v[136:139], v1, s[32:35], s63 offen nt
s_add_u32 s63, s63, s61
buffer_load_dwordx4 v[140:143], v1, s[32:35], s63 offen nt
s_waitcnt lgkmcnt(0)
s_barrier
s_mul_i32 s64, s3, 524288
s_add_u32 s64, s64, 4096
s_mul_i32 s65, s3, 25600
v_mul_u32_u24 v11, 160, v3
v_lshl_add_u32 v11, v9, 4, v11
v_add_u32 v11, s65, v11
v_bfe_u32 v12, v0, 2, 2
v_lshl_add_u32 v12, v10, 3, v12
v_mul_u32_u24 v12, 160, v12
v_and_b32 v13, 3, v0
v_lshl_add_u32 v12, v13, 3, v12
v_add_u32 v12, s65, v12
v_and_b32 v13, 15, v0
v_lshlrev_b32 v13, 4, v13
v_lshl_add_u32 v13, v10, 13, v13
v_add_u32 v13, 4096, v13
s_lshl_b32 s62, s31, 14
s_add_u32 s64, s64, s62
s_lshl_b32 s62, s59, 10
s_lshl_b32 s63, s58, 8
s_add_u32 s62, s62, s63
s_add_u32 s62, s62, s64
s_add_u32 s66, s28, s62
s_addc_u32 s67, s29, 0
s_lshl_b32 s62, s30, 11
s_add_u32 s62, s62, s64
s_add_u32 s68, s28, s62
s_addc_u32 s69, s29, 0
s_add_u32 s56, s56, 0x01010101
v_mov_b32 v14, s56
s_lshl_b32 s63, s31, 8
s_add_u32 s63, s63, 1572864
s_getreg_b32 s57, hwreg(HW_REG_XCC_ID, 0, 4)
s_add_u32 s46, s28, s63
s_addc_u32 s47, s29, 0
s_add_u32 s57, s57, s56
s_mov_b32 s40, 117835008
s_mov_b32 s41, 117835009
s_mov_b32 s42, 117835010
s_mov_b32 s43, 117835011
s_mov_b32 s44, 0x0c0c0400
s_mov_b32 s45, 0x04000c0c
s_waitcnt vmcnt(24)
ds_write_b128 v11, v[64:67] offset:0
s_waitcnt vmcnt(23)
ds_write_b128 v11, v[68:71] offset:1280
s_waitcnt vmcnt(22)
ds_write_b128 v11, v[72:75] offset:2560
s_waitcnt vmcnt(16)
ds_write_b128 v11, v[76:79] offset:3840
ds_read_b64_tr_b16 v[144:145], v12 offset:0
ds_read_b64_tr_b16 v[146:147], v12 offset:640
ds_read_b64_tr_b16 v[148:149], v12 offset:32
ds_read_b64_tr_b16 v[150:151], v12 offset:672
ds_read_b64_tr_b16 v[152:153], v12 offset:64
ds_read_b64_tr_b16 v[154:155], v12 offset:704
ds_read_b64_tr_b16 v[156:157], v12 offset:96
ds_read_b64_tr_b16 v[158:159], v12 offset:736
s_waitcnt lgkmcnt(0)
v_mfma_f32_16x16x32_bf16 v[16:19], v[224:227], v[144:147], 0
v_mfma_f32_16x16x32_bf16 v[20:23], v[224:227], v[148:151], 0
v_mfma_f32_16x16x32_bf16 v[24:27], v[224:227], v[152:155], 0
v_mfma_f32_16x16x32_bf16 v[28:31], v[224:227], v[156:159], 0
s_waitcnt vmcnt(15)
ds_write_b128 v11, v[80:83] offset:5120
s_waitcnt vmcnt(14)
ds_write_b128 v11, v[84:87] offset:6400
s_waitcnt vmcnt(13)
ds_write_b128 v11, v[88:91] offset:7680
s_waitcnt vmcnt(12)
ds_write_b128 v11, v[92:95] offset:8960
ds_read_b64_tr_b16 v[160:161], v12 offset:5120
ds_read_b64_tr_b16 v[162:163], v12 offset:5760
ds_read_b64_tr_b16 v[164:165], v12 offset:5152
ds_read_b64_tr_b16 v[166:167], v12 offset:5792
ds_read_b64_tr_b16 v[168:169], v12 offset:5184
ds_read_b64_tr_b16 v[170:171], v12 offset:5824
ds_read_b64_tr_b16 v[172:173], v12 offset:5216
ds_read_b64_tr_b16 v[174:175], v12 offset:5856
s_waitcnt lgkmcnt(0)
v_mfma_f32_16x16x32_bf16 v[16:19], v[228:231], v[160:163], v[16:19]
v_mfma_f32_16x16x32_bf16 v[20:23], v[228:231], v[164:167], v[20:23]
v_mfma_f32_16x16x32_bf16 v[24:27], v[228:231], v[168:171], v[24:27]
v_mfma_f32_16x16x32_bf16 v[28:31], v[228:231], v[172:175], v[28:31]
s_waitcnt vmcnt(11)
ds_write_b128 v11, v[96:99] offset:10240
s_waitcnt vmcnt(10)
ds_write_b128 v11, v[100:103] offset:11520
s_waitcnt vmcnt(9)
ds_write_b128 v11, v[104:107] offset:12800
s_waitcnt vmcnt(8)
ds_write_b128 v11, v[108:111] offset:14080
ds_read_b64_tr_b16 v[176:177], v12 offset:10240
ds_read_b64_tr_b16 v[178:179], v12 offset:10880
ds_read_b64_tr_b16 v[180:181], v12 offset:10272
ds_read_b64_tr_b16 v[182:183], v12 offset:10912
ds_read_b64_tr_b16 v[184:185], v12 offset:10304
ds_read_b64_tr_b16 v[186:187], v12 offset:10944
ds_read_b64_tr_b16 v[188:189], v12 offset:10336
ds_read_b64_tr_b16 v[190:191], v12 offset:10976
s_waitcnt lgkmcnt(0)
v_mfma_f32_16x16x32_bf16 v[16:19], v[232:235], v[176:179], v[16:19]
v_mfma_f32_16x16x32_bf16 v[20:23], v[232:235], v[180:183], v[20:23]
v_mfma_f32_16x16x32_bf16 v[24:27], v[232:235], v[184:187], v[24:27]
v_mfma_f32_16x16x32_bf16 v[28:31], v[232:235], v[188:191], v[28:31]
s_waitcnt vmcnt(7)
ds_write_b128 v11, v[112:115] offset:15360
s_waitcnt vmcnt(6)
ds_write_b128 v11, v[116:119] offset:16640
s_waitcnt vmcnt(5)
ds_write_b128 v11, v[120:123] offset:17920
s_waitcnt vmcnt(4)
ds_write_b128 v11, v[124:127] offset:19200
ds_read_b64_tr_b16 v[192:193], v12 offset:15360
ds_read_b64_tr_b16 v[194:195], v12 offset:16000
ds_read_b64_tr_b16 v[196:197], v12 offset:15392
ds_read_b64_tr_b16 v[198:199], v12 offset:16032
ds_read_b64_tr_b16 v[200:201], v12 offset:15424
ds_read_b64_tr_b16 v[202:203], v12 offset:16064
ds_read_b64_tr_b16 v[204:205], v12 offset:15456
ds_read_b64_tr_b16 v[206:207], v12 offset:16096
s_waitcnt lgkmcnt(0)
v_mfma_f32_16x16x32_bf16 v[16:19], v[236:239], v[192:195], v[16:19]
v_mfma_f32_16x16x32_bf16 v[20:23], v[236:239], v[196:199], v[20:23]
v_mfma_f32_16x16x32_bf16 v[24:27], v[236:239], v[200:203], v[24:27]
v_mfma_f32_16x16x32_bf16 v[28:31], v[236:239], v[204:207], v[28:31]
s_waitcnt vmcnt(3)
ds_write_b128 v11, v[128:131] offset:20480
s_waitcnt vmcnt(2)
ds_write_b128 v11, v[132:135] offset:21760
s_waitcnt vmcnt(1)
ds_write_b128 v11, v[136:139] offset:23040
s_waitcnt vmcnt(0)
ds_write_b128 v11, v[140:143] offset:24320
ds_read_b64_tr_b16 v[208:209], v12 offset:20480
ds_read_b64_tr_b16 v[210:211], v12 offset:21120
ds_read_b64_tr_b16 v[212:213], v12 offset:20512
ds_read_b64_tr_b16 v[214:215], v12 offset:21152
ds_read_b64_tr_b16 v[216:217], v12 offset:20544
ds_read_b64_tr_b16 v[218:219], v12 offset:21184
ds_read_b64_tr_b16 v[220:221], v12 offset:20576
ds_read_b64_tr_b16 v[222:223], v12 offset:21216
s_waitcnt lgkmcnt(0)
v_mfma_f32_16x16x32_bf16 v[16:19], v[240:243], v[208:211], v[16:19]
v_mfma_f32_16x16x32_bf16 v[20:23], v[240:243], v[212:215], v[20:23]
v_mfma_f32_16x16x32_bf16 v[24:27], v[240:243], v[216:219], v[24:27]
v_mfma_f32_16x16x32_bf16 v[28:31], v[240:243], v[220:223], v[28:31]
s_load_dwordx8 s[48:55], s[46:47], 0 glc
s_cmp_eq_u32 s3, 0
s_cbranch_scc1 L_nog
s_mul_i32 s62, s30, 1280
s_add_u32 s60, s4, s62
s_addc_u32 s61, s5, 0
v_lshlrev_b32 v2, 2, v0
global_load_dword v52, v2, s[60:61] offset:0
global_load_dword v57, v2, s[22:23] offset:0
global_load_dword v53, v2, s[60:61] offset:256
global_load_dword v58, v2, s[22:23] offset:256
global_load_dword v54, v2, s[60:61] offset:512
global_load_dword v59, v2, s[22:23] offset:512
global_load_dword v55, v2, s[60:61] offset:768
global_load_dword v60, v2, s[22:23] offset:768
global_load_dword v56, v2, s[60:61] offset:1024
global_load_dword v61, v2, s[22:23] offset:1024
L_nog:
s_nop 7
v_perm_b32 v144, v16, v14, s40
v_perm_b32 v145, v20, v14, s41
v_perm_b32 v146, v24, v14, s42
v_perm_b32 v147, v28, v14, s43
v_perm_b32 v148, v17, v14, s40
v_perm_b32 v149, v21, v14, s41
v_perm_b32 v150, v25, v14, s42
v_perm_b32 v151, v29, v14, s43
v_perm_b32 v152, v18, v14, s40
v_perm_b32 v153, v22, v14, s41
v_perm_b32 v154, v26, v14, s42
v_perm_b32 v155, v30, v14, s43
v_perm_b32 v156, v19, v14, s40
v_perm_b32 v157, v23, v14, s41
v_perm_b32 v158, v27, v14, s42
v_perm_b32 v159, v31, v14, s43
s_mov_b32 exec_hi, 0
s_mov_b32 s98, 0
s_branch L_xw_in
L_xw:
s_load_dwordx8 s[48:55], s[46:47], 0 glc
L_xw_in:
s_waitcnt lgkmcnt(0)
s_xor_b32 s48, s48, s57
s_xor_b32 s49, s49, s57
s_xor_b32 s50, s50, s57
s_xor_b32 s51, s51, s57
s_xor_b32 s52, s52, s57
s_xor_b32 s53, s53, s57
s_xor_b32 s54, s54, s57
s_xor_b32 s55, s55, s57
s_or_b64 s[48:49], s[48:49], s[50:51]
s_or_b64 s[52:53], s[52:53], s[54:55]
s_or_b64 s[48:49], s[48:49], s[52:53]
s_cbranch_scc0 L_same
s_add_u32 s98, s98, 1
s_cmp_lt_u32 s98, 6
s_cbranch_scc1 L_xw
global_store_dwordx4 v13, v[144:147], s[66:67] offset:-4096 sc1
global_store_dwordx4 v13, v[148:151], s[66:67] offset:-2048 sc1
global_store_dwordx4 v13, v[152:155], s[66:67] offset:0 sc1
global_store_dwordx4 v13, v[156:159], s[66:67] offset:2048 sc1
s_branch L_pubd
L_same:
global_store_dwordx4 v13, v[144:147], s[66:67] offset:-4096
global_store_dwordx4 v13, v[148:151], s[66:67] offset:-2048
global_store_dwordx4 v13, v[152:155], s[66:67] offset:0
global_store_dwordx4 v13, v[156:159], s[66:67] offset:2048
L_pubd:
s_mov_b64 exec, -1
v_lshlrev_b32 v15, 4, v0
v_lshrrev_b32 v10, 4, v0
v_lshrrev_b32 v1, 5, v0
v_lshlrev_b32 v1, 2, v1
v_bfe_u32 v3, v0, 3, 1
v_lshl_add_u32 v1, v3, 1, v1
v_and_b32 v3, 1, v10
v_add_u32 v1, v1, v3
v_mul_u32_u24 v1, 1280, v1
v_and_b32 v3, 7, v0
v_lshl_add_u32 v1, v3, 4, v1
s_lshl_b32 s57, s3, 8
s_mul_i32 s62, s31, 163840
s_add_u32 s62, s62, s57
s_add_u32 s32, s12, s62
s_addc_u32 s33, s13, 0
s_sub_u32 s34, 163840, s57
s_mov_b32 s35, 0x20000
s_sub_u32 s63, s31, 8
s_cmp_ge_u32 s31, 27
s_cselect_b32 s63, s63, s31
s_mul_i32 s62, s63, 81920
s_add_u32 s62, s62, s57
s_add_u32 s36, s20, s62
s_addc_u32 s37, s21, 0
s_sub_u32 s38, 81920, s57
s_mov_b32 s39, 0x20000
v_bfe_u32 v3, v0, 2, 1
v_cmp_eq_u32 vcc, 0, v3
v_mov_b32 v48, 0xffff
v_mov_b32 v49, 0xffff0000
v_cndmask_b32 v4, 0, v48, vcc
v_cndmask_b32 v6, 0, v49, vcc
v_xor_b32 v5, v4, v48
v_xor_b32 v7, v6, v49
v_and_b32 v9, 3, v0
v_mul_u32_u24 v9, 0x5555, v9
s_waitcnt vmcnt(2)
s_mov_b32 s48, 0
buffer_load_dwordx4 v[64:67], v1, s[32:35], s48 offen offset:0 nt
s_waitcnt vmcnt(2)
buffer_load_dwordx4 v[72:75], v1, s[32:35], s48 offen offset:128 nt
s_mov_b32 s98, 0
L_poll1:
global_load_dwordx4 v[40:43], v15, s[68:69] sc1
global_load_dwordx4 v[44:47], v15, s[68:69] offset:1024 sc1
s_waitcnt vmcnt(0)
v_perm_b32 v48, v41, v40, s44
v_perm_b32 v49, v43, v42, s45
v_or_b32 v48, v48, v49
v_xor_b32 v50, v48, v14
v_perm_b32 v48, v45, v44, s44
v_perm_b32 v49, v47, v46, s45
v_or_b32 v48, v48, v49
v_xor_b32 v48, v48, v14
v_or_b32 v50, v50, v48
v_cmp_ne_u32 vcc, 0, v50
s_nop 4
s_cbranch_vccz L_poll1_ok
s_add_u32 s98, s98, 1
s_cmp_lt_u32 s98, 262144
s_cbranch_scc1 L_poll1
L_poll1_ok:
s_mov_b32 s48, 10240
buffer_load_dwordx4 v[68:71], v1, s[32:35], s48 offen offset:0 nt
buffer_load_dwordx4 v[76:79], v1, s[32:35], s48 offen offset:128 nt
s_mov_b32 s48, 20480
buffer_load_dwordx4 v[80:83], v1, s[32:35], s48 offen offset:0 nt
buffer_load_dwordx4 v[88:91], v1, s[32:35], s48 offen offset:128 nt
v_and_b32 v40, 0xffffff00, v40
v_and_b32 v41, 0xffffff00, v41
v_and_b32 v42, 0xffffff00, v42
v_and_b32 v43, 0xffffff00, v43
v_and_b32 v44, 0xffffff00, v44
v_and_b32 v45, 0xffffff00, v45
v_and_b32 v46, 0xffffff00, v46
v_and_b32 v47, 0xffffff00, v47
v_permlane16_swap_b32 v40, v41
v_permlane16_swap_b32 v42, v43
v_add_f32 v40, v40, v41
v_add_f32 v42, v42, v43
s_nop 1
v_permlane32_swap_b32 v40, v42
v_add_f32 v40, v40, v42
v_permlane16_swap_b32 v44, v45
v_permlane16_swap_b32 v46, v47
v_add_f32 v44, v44, v45
v_add_f32 v46, v46, v47
s_nop 1
v_permlane32_swap_b32 v44, v46
v_add_f32 v44, v44, v46
v_cvt_pk_bf16_f32 v40, v40, v44
v_lshlrev_b32 v48, 1, v0
v_add_u32 v48, 51200, v48
s_cmp_eq_u32 s3, 1
s_cbranch_scc1 L_ffn
ds_write_b16 v48, v40
ds_write_b16_d16_hi v48, v40 offset:128
s_branch L_pa_flag
L_pa_skip:
s_lshl_b32 s62, s31, 3
s_add_u32 s62, s62, s30
s_mul_i32 s62, s62, 10240
v_lshlrev_b32 v2, 7, v0
v_add_u32 v2, s62, v2
s_bfm_b64 exec, 40, 0
v_subrev_u32 v3, 655360, v2
global_load_dword v63, v3, s[20:21]
v_add_u32 v3, 5120, v3
global_load_dword v63, v3, s[20:21]
v_subrev_u32 v3, 1310720, v2
global_load_dword v63, v3, s[20:21]
v_add_u32 v3, 5120, v3
global_load_dword v63, v3, s[20:21]
v_subrev_u32 v3, 1966080, v2
global_load_dword v63, v3, s[20:21]
v_add_u32 v3, 5120, v3
global_load_dword v63, v3, s[20:21]
s_mov_b64 exec, -1
s_cmp_lg_u32 s31, 31
s_cbranch_scc1 L_noinit
s_mul_i32 s62, s30, 5120
s_add_u32 s62, s62, 1054720
s_add_u32 s66, s28, s62
s_addc_u32 s67, s29, 0
v_lshlrev_b32 v2, 4, v0
v_mov_b32 v44, 0
v_mov_b32 v45, 0
v_mov_b32 v46, 0
v_mov_b32 v47, 0
global_store_dwordx4 v2, v[44:47], s[66:67] offset:-2048 sc1
global_store_dwordx4 v2, v[44:47], s[66:67] offset:-1024 sc1
global_store_dwordx4 v2, v[44:47], s[66:67] offset:0 sc1
global_store_dwordx4 v2, v[44:47], s[66:67] offset:1024 sc1
global_store_dwordx4 v2, v[44:47], s[66:67] offset:2048 sc1
L_noinit:
s_waitcnt lgkmcnt(0)
s_barrier
s_add_u32 s56, s56, 0x01010101
s_cmp_lg_u32 s31, 31
s_cbranch_scc1 L_noflag
s_lshl_b32 s62, s30, 7
s_add_u32 s62, s62, 1024
v_mov_b32 v2, s62
v_mov_b32 v3, s56
s_waitcnt vmcnt(0)
s_mov_b64 exec, 1
global_store_dword v2, v3, s[28:29] sc1
s_mov_b64 exec, -1
L_noflag:
s_mul_i32 s62, s30, 1280
s_add_u32 s60, s4, s62
s_addc_u32 s61, s5, 0
v_lshlrev_b32 v2, 2, v0
global_load_dword v52, v2, s[60:61] offset:0
global_load_dword v57, v2, s[22:23] offset:0
global_load_dword v53, v2, s[60:61] offset:256
global_load_dword v58, v2, s[22:23] offset:256
global_load_dword v54, v2, s[60:61] offset:512
global_load_dword v59, v2, s[22:23] offset:512
global_load_dword v55, v2, s[60:61] offset:768
global_load_dword v60, v2, s[22:23] offset:768
global_load_dword v56, v2, s[60:61] offset:1024
global_load_dword v61, v2, s[22:23] offset:1024
v_lshrrev_b32 v10, 4, v0
v_lshrrev_b32 v1, 5, v0
v_lshlrev_b32 v1, 2, v1
v_bfe_u32 v3, v0, 3, 1
v_lshl_add_u32 v1, v3, 1, v1
v_and_b32 v3, 1, v10
v_add_u32 v1, v1, v3
v_mul_u32_u24 v1, 1280, v1
v_and_b32 v3, 7, v0
v_lshl_add_u32 v1, v3, 4, v1
s_lshl_b32 s57, s3, 8
s_mul_i32 s62, s31, 163840
s_add_u32 s62, s62, s57
s_add_u32 s32, s12, s62
s_addc_u32 s33, s13, 0
s_sub_u32 s34, 163840, s57
s_mov_b32 s35, 0x20000
s_sub_u32 s63, s31, 8
s_cmp_ge_u32 s31, 27
s_cselect_b32 s63, s63, s31
s_mul_i32 s62, s63, 81920
s_add_u32 s62, s62, s57
s_add_u32 s36, s20, s62
s_addc_u32 s37, s21, 0
s_sub_u32 s38, 81920, s57
s_mov_b32 s39, 0x20000
v_bfe_u32 v3, v0, 2, 1
v_cmp_eq_u32 vcc, 0, v3
v_mov_b32 v48, 0xffff
v_mov_b32 v49, 0xffff0000
v_cndmask_b32 v4, 0, v48, vcc
v_cndmask_b32 v6, 0, v49, vcc
v_xor_b32 v5, v4, v48
v_xor_b32 v7, v6, v49
v_and_b32 v9, 3, v0
v_mul_u32_u24 v9, 0x5555, v9
s_waitcnt vmcnt(0)
s_waitcnt vmcnt(2)
s_mov_b32 s48, 0
buffer_load_dwordx4 v[64:67], v1, s[32:35], s48 offen offset:0 nt
s_waitcnt vmcnt(2)
buffer_load_dwordx4 v[72:75], v1, s[32:35], s48 offen offset:128 nt
s_waitcnt vmcnt(2)
s_mov_b32 s48, 10240
buffer_load_dwordx4 v[68:71], v1, s[32:35], s48 offen offset:0 nt
s_waitcnt vmcnt(2)
buffer_load_dwordx4 v[76:79], v1, s[32:35], s48 offen offset:128 nt
s_waitcnt vmcnt(2)
s_mov_b32 s48, 20480
buffer_load_dwordx4 v[80:83], v1, s[32:35], s48 offen offset:0 nt
s_waitcnt vmcnt(2)
buffer_load_dwordx4 v[88:91], v1, s[32:35], s48 offen offset:128 nt
v_lshlrev_b32 v48, 1, v0
v_add_u32 v48, 51200, v48
v_mov_b32 v40, 0
L_ffn:
v_lshlrev_b32 v41, 16, v40
v_and_b32 v42, 0xffff0000, v40
v_mul_f32 v43, 3216550459, v41
v_exp_f32 v43, v43
s_nop 0
v_add_f32 v43, 1.0, v43
v_rcp_f32 v43, v43
s_nop 0
v_mul_f32 v43, v41, v43
v_cvt_pk_bf16_f32 v43, v43, v43
v_lshlrev_b32 v43, 16, v43
v_mul_f32 v43, v43, v42
v_cvt_pk_bf16_f32 v43, v43, v43
ds_write_b16 v48, v43 offset:256
v_mov_b32 v36, 0
v_lshlrev_b32 v41, 16, v52
v_and_b32 v42, 0xffff0000, v52
v_lshlrev_b32 v43, 16, v57
v_and_b32 v44, 0xffff0000, v57
v_mul_f32 v41, v41, v43
v_mul_f32 v42, v42, v44
v_cvt_pk_bf16_f32 v41, v41, v42
v_lshlrev_b32 v42, 16, v41
v_and_b32 v41, 0xffff0000, v41
v_add_f32 v36, v36, v42
v_add_f32 v36, v36, v41
v_lshlrev_b32 v41, 16, v53
v_and_b32 v42, 0xffff0000, v53
v_lshlrev_b32 v43, 16, v58
v_and_b32 v44, 0xffff0000, v58
v_mul_f32 v41, v41, v43
v_mul_f32 v42, v42, v44
v_cvt_pk_bf16_f32 v41, v41, v42
v_lshlrev_b32 v42, 16, v41
v_and_b32 v41, 0xffff0000, v41
v_add_f32 v36, v36, v42
v_add_f32 v36, v36, v41
v_lshlrev_b32 v41, 16, v54
v_and_b32 v42, 0xffff0000, v54
v_lshlrev_b32 v43, 16, v59
v_and_b32 v44, 0xffff0000, v59
v_mul_f32 v41, v41, v43
v_mul_f32 v42, v42, v44
v_cvt_pk_bf16_f32 v41, v41, v42
v_lshlrev_b32 v42, 16, v41
v_and_b32 v41, 0xffff0000, v41
v_add_f32 v36, v36, v42
v_add_f32 v36, v36, v41
v_lshlrev_b32 v41, 16, v55
v_and_b32 v42, 0xffff0000, v55
v_lshlrev_b32 v43, 16, v60
v_and_b32 v44, 0xffff0000, v60
v_mul_f32 v41, v41, v43
v_mul_f32 v42, v42, v44
v_cvt_pk_bf16_f32 v41, v41, v42
v_lshlrev_b32 v42, 16, v41
v_and_b32 v41, 0xffff0000, v41
v_add_f32 v36, v36, v42
v_add_f32 v36, v36, v41
v_lshlrev_b32 v41, 16, v56
v_and_b32 v42, 0xffff0000, v56
v_lshlrev_b32 v43, 16, v61
v_and_b32 v44, 0xffff0000, v61
v_mul_f32 v41, v41, v43
v_mul_f32 v42, v42, v44
v_cvt_pk_bf16_f32 v41, v41, v42
v_lshlrev_b32 v42, 16, v41
v_and_b32 v41, 0xffff0000, v41
v_add_f32 v36, v36, v42
v_add_f32 v36, v36, v41
s_nop 1
v_add_f32_dpp v36, v36, v36 row_ror:1 row_mask:0xf bank_mask:0xf
s_nop 1
v_add_f32_dpp v36, v36, v36 row_ror:2 row_mask:0xf bank_mask:0xf
s_nop 1
v_add_f32_dpp v36, v36, v36 row_ror:4 row_mask:0xf bank_mask:0xf
s_nop 1
v_add_f32_dpp v36, v36, v36 row_ror:8 row_mask:0xf bank_mask:0xf
v_mov_b32 v41, v36
s_nop 1
v_permlane16_swap_b32 v36, v41
v_add_f32 v36, v36, v41
v_mov_b32 v41, v36
s_nop 1
v_permlane32_swap_b32 v36, v41
v_add_f32 v36, v36, v41
v_cvt_pk_bf16_f32 v36, v36, v36
v_lshlrev_b32 v36, 16, v36
v_mul_f32 v36, 3216550459, v36
v_exp_f32 v36, v36
s_nop 0
v_add_f32 v36, 1.0, v36
v_rcp_f32 v36, v36
s_nop 0
v_cvt_pk_bf16_f32 v36, v36, v36
v_lshlrev_b32 v36, 16, v36
v_sub_f32 v37, 1.0, v36
v_cvt_pk_bf16_f32 v37, v37, v37
v_lshlrev_b32 v37, 16, v37
v_mov_b32 v48, 51712
ds_write_b64 v48, v[36:37]
L_pa_flag:
s_lshl_b32 s62, s3, 2
s_add_u32 s62, s62, 51776
v_mov_b32 v48, s62
v_mov_b32 v49, 1
s_waitcnt lgkmcnt(0)
ds_write_b32 v48, v49
s_setprio 0
s_waitcnt vmcnt(2)
s_mov_b32 s48, 30720
buffer_load_dwordx4 v[84:87], v1, s[32:35], s48 offen offset:0 nt
s_waitcnt vmcnt(2)
buffer_load_dwordx4 v[92:95], v1, s[32:35], s48 offen offset:128 nt
s_waitcnt vmcnt(2)
s_mov_b32 s48, 40960
buffer_load_dwordx4 v[96:99], v1, s[32:35], s48 offen offset:0 nt
s_waitcnt vmcnt(2)
buffer_load_dwordx4 v[104:107], v1, s[32:35], s48 offen offset:128 nt
s_waitcnt vmcnt(2)
s_mov_b32 s48, 51200
buffer_load_dwordx4 v[100:103], v1, s[32:35], s48 offen offset:0 nt
s_waitcnt vmcnt(2)
buffer_load_dwordx4 v[108:111], v1, s[32:35], s48 offen offset:128 nt
s_waitcnt vmcnt(2)
s_mov_b32 s48, 0
buffer_load_dwordx4 v[128:131], v1, s[36:39], s48 offen offset:0 nt
s_waitcnt vmcnt(2)
buffer_load_dwordx4 v[136:139], v1, s[36:39], s48 offen offset:128 nt
s_waitcnt vmcnt(2)
s_mov_b32 s48, 10240
buffer_load_dwordx4 v[132:135], v1, s[36:39], s48 offen offset:0 nt
s_waitcnt vmcnt(2)
buffer_load_dwordx4 v[140:143], v1, s[36:39], s48 offen offset:128 nt
s_waitcnt vmcnt(2)
s_mov_b32 s48, 20480
buffer_load_dwordx4 v[144:147], v1, s[36:39], s48 offen offset:0 nt
s_waitcnt vmcnt(2)
buffer_load_dwordx4 v[152:155], v1, s[36:39], s48 offen offset:128 nt
s_waitcnt vmcnt(2)
s_mov_b32 s48, 30720
buffer_load_dwordx4 v[148:151], v1, s[36:39], s48 offen offset:0 nt
s_waitcnt vmcnt(2)
buffer_load_dwordx4 v[156:159], v1, s[36:39], s48 offen offset:128 nt
s_waitcnt vmcnt(2)
s_mov_b32 s48, 40960
buffer_load_dwordx4 v[160:163], v1, s[36:39], s48 offen offset:0 nt
s_waitcnt vmcnt(2)
buffer_load_dwordx4 v[168:171], v1, s[36:39], s48 offen offset:128 nt
s_waitcnt vmcnt(2)
s_mov_b32 s48, 51200
buffer_load_dwordx4 v[164:167], v1, s[36:39], s48 offen offset:0 nt
s_waitcnt vmcnt(2)
buffer_load_dwordx4 v[172:175], v1, s[36:39], s48 offen offset:128 nt
s_waitcnt vmcnt(2)
s_mov_b32 s48, 61440
buffer_load_dwordx4 v[176:179], v1, s[36:39], s48 offen offset:0 nt
s_waitcnt vmcnt(2)
buffer_load_dwordx4 v[184:187], v1, s[36:39], s48 offen offset:128 nt
s_waitcnt vmcnt(2)
s_mov_b32 s48, 71680
buffer_load_dwordx4 v[180:183], v1, s[36:39], s48 offen offset:0 nt
s_waitcnt vmcnt(2)
buffer_load_dwordx4 v[188:191], v1, s[36:39], s48 offen offset:128 nt
s_waitcnt vmcnt(2)
s_mov_b32 s48, 61440
buffer_load_dwordx4 v[112:115], v1, s[32:35], s48 offen offset:0 nt
s_waitcnt vmcnt(2)
buffer_load_dwordx4 v[120:123], v1, s[32:35], s48 offen offset:128 nt
s_waitcnt vmcnt(2)
s_mov_b32 s48, 71680
buffer_load_dwordx4 v[116:119], v1, s[32:35], s48 offen offset:0 nt
s_waitcnt vmcnt(2)
buffer_load_dwordx4 v[124:127], v1, s[32:35], s48 offen offset:128 nt
v_mov_b32 v48, 51776
s_mov_b32 s98, 0
L_hwaita:
ds_read_b32 v51, v48 offset:4
s_waitcnt lgkmcnt(0)
v_cmp_eq_u32 vcc, 0, v51
s_nop 4
s_cbranch_vccz L_hwaita_ok
s_add_u32 s98, s98, 1
s_cmp_lt_u32 s98, 4194304
s_cbranch_scc1 L_hwaita
L_hwaita_ok:
v_and_b32 v48, 3, v0
v_lshlrev_b32 v48, 5, v48
v_lshrrev_b32 v49, 3, v0
v_lshl_add_u32 v48, v49, 2, v48
v_add_u32 v48, 51456, v48
ds_read_b32 v8, v48
v_mov_b32 v48, 51712
ds_read_b64 v[36:37], v48
v_mov_b32 v12, 0
v_mov_b32 v13, 0
v_mov_b32 v14, 0
v_mov_b32 v15, 0
v_mov_b32 v16, 0
v_mov_b32 v17, 0
v_mov_b32 v18, 0
v_mov_b32 v19, 0
s_waitcnt vmcnt(2) lgkmcnt(0)
v_mov_b32_dpp v11, v8 row_newbcast:0 row_mask:0xf bank_mask:0x3
v_mov_b32_dpp v11, v8 row_newbcast:8 row_mask:0xf bank_mask:0xc
v_and_b32 v24, v11, v4
v_and_b32 v25, v11, v5
v_and_b32 v26, v11, v6
v_and_b32 v27, v11, v7
s_nop 1
v_smfmac_f32_16x16x64_bf16 v[12:15], v[24:27], v[128:135], v9
v_mov_b32_dpp v11, v8 row_newbcast:1 row_mask:0xf bank_mask:0x3
v_mov_b32_dpp v11, v8 row_newbcast:9 row_mask:0xf bank_mask:0xc
v_and_b32 v28, v11, v4
v_and_b32 v29, v11, v5
v_and_b32 v30, v11, v6
v_and_b32 v31, v11, v7
v_smfmac_f32_16x16x64_bf16 v[16:19], v[24:27], v[136:143], v9
s_nop 0
v_smfmac_f32_16x16x64_bf16 v[12:15], v[28:31], v[144:151], v9
v_mov_b32_dpp v11, v8 row_newbcast:2 row_mask:0xf bank_mask:0x3
v_mov_b32_dpp v11, v8 row_newbcast:10 row_mask:0xf bank_mask:0xc
v_and_b32 v24, v11, v4
v_and_b32 v25, v11, v5
v_and_b32 v26, v11, v6
v_and_b32 v27, v11, v7
v_smfmac_f32_16x16x64_bf16 v[16:19], v[28:31], v[152:159], v9
s_nop 0
v_smfmac_f32_16x16x64_bf16 v[12:15], v[24:27], v[160:167], v9
v_mov_b32_dpp v11, v8 row_newbcast:3 row_mask:0xf bank_mask:0x3
v_mov_b32_dpp v11, v8 row_newbcast:11 row_mask:0xf bank_mask:0xc
v_and_b32 v28, v11, v4
v_and_b32 v29, v11, v5
v_and_b32 v30, v11, v6
v_and_b32 v31, v11, v7
v_smfmac_f32_16x16x64_bf16 v[16:19], v[24:27], v[168:175], v9
s_nop 0
v_smfmac_f32_16x16x64_bf16 v[12:15], v[28:31], v[176:183], v9
v_smfmac_f32_16x16x64_bf16 v[16:19], v[28:31], v[184:191], v9
s_waitcnt vmcnt(2)
s_mov_b32 s48, 81920
buffer_load_dwordx4 v[128:131], v1, s[32:35], s48 offen offset:0 nt
s_waitcnt vmcnt(2)
buffer_load_dwordx4 v[136:139], v1, s[32:35], s48 offen offset:128 nt
v_mov_b32 v56, 0
v_mov_b32 v57, 0
v_mov_b32 v58, 0
v_mov_b32 v59, 0
s_nop 2
v_permlane32_swap_b32 v12, v16
v_permlane32_swap_b32 v13, v17
v_permlane32_swap_b32 v14, v18
v_permlane32_swap_b32 v15, v19
v_add_f32_dpp v56, v16, v12 row_ror:8 row_mask:0xf bank_mask:0x3
v_add_f32_dpp v57, v17, v13 row_ror:8 row_mask:0xf bank_mask:0x3
v_add_f32_dpp v58, v18, v14 row_ror:8 row_mask:0xf bank_mask:0x3
v_add_f32_dpp v59, v19, v15 row_ror:8 row_mask:0xf bank_mask:0x3
v_bfe_u32 v3, v0, 3, 1
v_cvt_f32_u32 v48, v3
v_cmp_eq_u32 vcc, 0, v3
s_nop 1
v_cndmask_b32 v36, 0, v36, vcc
v_cndmask_b32 v37, 0, v37, vcc
v_fma_f32 v50, v56, v37, v48
v_fma_f32 v51, v57, v37, v48
v_fma_f32 v52, v58, v37, v48
v_fma_f32 v53, v59, v37, v48
v_mov_b32 v12, 0
v_mov_b32 v13, 0
v_mov_b32 v14, 0
v_mov_b32 v15, 0
v_mov_b32 v16, 0
v_mov_b32 v17, 0
v_mov_b32 v18, 0
v_mov_b32 v19, 0
v_and_b32 v2, 7, v0
v_lshlrev_b32 v2, 6, v2
v_lshrrev_b32 v48, 3, v0
v_lshl_add_u32 v2, v48, 3, v2
v_add_u32 v2, 52224, v2
v_lshlrev_b32 v39, 6, v10
v_and_b32 v48, 7, v0
v_lshl_add_u32 v39, v48, 3, v39
v_lshl_add_u32 v39, v3, 2, v39
s_mul_i32 s62, s30, 5120
s_lshl_b32 s63, s57, 2
s_add_u32 s62, s62, s63
s_add_u32 s62, s62, 1052672
s_add_u32 s66, s28, s62
s_addc_u32 s67, s29, 0
v_lshlrev_b32 v48, 4, v48
v_and_b32 v49, 1, v10
v_lshl_add_u32 v48, v49, 3, v48
v_lshrrev_b32 v49, 5, v0
v_lshl_add_u32 v38, v49, 7, v48
v_lshl_add_u32 v37, v49, 2, v48
s_mul_i32 s62, s30, 1280
s_add_u32 s62, s62, s57
s_add_u32 s60, s24, s62
s_addc_u32 s61, s25, 0
s_mov_b32 s46, 0x00ff00ff
s_mov_b32 s47, 0x00ff00ff
s_mov_b32 s49, 0x41f80000
s_lshl_b32 s62, s30, 7
s_add_u32 s62, s62, 1024
v_mov_b32 v48, s62
global_load_dword v49, v48, s[28:29] sc1
s_waitcnt vmcnt(2)
s_mov_b32 s48, 92160
buffer_load_dwordx4 v[132:135], v1, s[32:35], s48 offen offset:0 nt
s_waitcnt vmcnt(2)
buffer_load_dwordx4 v[140:143], v1, s[32:35], s48 offen offset:128 nt
s_waitcnt vmcnt(2)
s_mov_b32 s48, 102400
buffer_load_dwordx4 v[144:147], v1, s[32:35], s48 offen offset:0 nt
s_waitcnt vmcnt(2)
buffer_load_dwordx4 v[152:155], v1, s[32:35], s48 offen offset:128 nt
s_waitcnt vmcnt(2)
s_mov_b32 s48, 112640
buffer_load_dwordx4 v[148:151], v1, s[32:35], s48 offen offset:0 nt
s_waitcnt vmcnt(2)
buffer_load_dwordx4 v[156:159], v1, s[32:35], s48 offen offset:128 nt
s_waitcnt vmcnt(2)
s_mov_b32 s48, 122880
buffer_load_dwordx4 v[160:163], v1, s[32:35], s48 offen offset:0 nt
s_waitcnt vmcnt(2)
buffer_load_dwordx4 v[168:171], v1, s[32:35], s48 offen offset:128 nt
s_waitcnt vmcnt(2)
s_mov_b32 s48, 133120
buffer_load_dwordx4 v[164:167], v1, s[32:35], s48 offen offset:0 nt
s_waitcnt vmcnt(2)
buffer_load_dwordx4 v[172:175], v1, s[32:35], s48 offen offset:128 nt
s_waitcnt vmcnt(2)
s_mov_b32 s48, 143360
buffer_load_dwordx4 v[176:179], v1, s[32:35], s48 offen offset:0 nt
s_waitcnt vmcnt(2)
buffer_load_dwordx4 v[184:187], v1, s[32:35], s48 offen offset:128 nt
s_waitcnt vmcnt(2)
s_mov_b32 s48, 153600
buffer_load_dwordx4 v[180:183], v1, s[32:35], s48 offen offset:0 nt
s_waitcnt vmcnt(2)
buffer_load_dwordx4 v[188:191], v1, s[32:35], s48 offen offset:128 nt
s_mov_b32 s98, 0
s_branch L_iwa_in
L_iwa:
global_load_dword v49, v48, s[28:29] sc1
L_iwa_in:
s_waitcnt vmcnt(0) lgkmcnt(0)
v_cmp_ne_u32 vcc, s56, v49
s_nop 4
s_cbranch_vccz L_iwa_ok
s_add_u32 s98, s98, 1
s_cmp_lt_u32 s98, 262144
s_cbranch_scc1 L_iwa
L_iwa_ok:
s_barrier
ds_read_b64 v[40:41], v2 offset:0
ds_read_b64 v[42:43], v2 offset:512
ds_read_b64 v[44:45], v2 offset:1024
ds_read_b64 v[46:47], v2 offset:1536
s_waitcnt lgkmcnt(0)
v_pk_add_f32 v[40:41], v[40:41], v[42:43]
v_pk_add_f32 v[44:45], v[44:45], v[46:47]
v_pk_add_f32 v[40:41], v[40:41], v[44:45]
v_cvt_pk_bf16_f32 v8, v40, v41
s_nop 1
v_mov_b32_dpp v11, v8 row_newbcast:0 row_mask:0xf bank_mask:0x3
v_mov_b32_dpp v11, v8 row_newbcast:8 row_mask:0xf bank_mask:0xc
v_and_b32 v24, v11, v4
v_and_b32 v25, v11, v5
v_and_b32 v26, v11, v6
v_and_b32 v27, v11, v7
s_nop 1
v_smfmac_f32_16x16x64_bf16 v[12:15], v[24:27], v[64:71], v9
v_mov_b32_dpp v11, v8 row_newbcast:1 row_mask:0xf bank_mask:0x3
v_mov_b32_dpp v11, v8 row_newbcast:9 row_mask:0xf bank_mask:0xc
v_and_b32 v28, v11, v4
v_and_b32 v29, v11, v5
v_and_b32 v30, v11, v6
v_and_b32 v31, v11, v7
v_smfmac_f32_16x16x64_bf16 v[16:19], v[24:27], v[72:79], v9
s_nop 0
v_smfmac_f32_16x16x64_bf16 v[12:15], v[28:31], v[80:87], v9
v_mov_b32_dpp v11, v8 row_newbcast:2 row_mask:0xf bank_mask:0x3
v_mov_b32_dpp v11, v8 row_newbcast:10 row_mask:0xf bank_mask:0xc
v_and_b32 v24, v11, v4
v_and_b32 v25, v11, v5
v_and_b32 v26, v11, v6
v_and_b32 v27, v11, v7
v_smfmac_f32_16x16x64_bf16 v[16:19], v[28:31], v[88:95], v9
s_nop 0
v_smfmac_f32_16x16x64_bf16 v[12:15], v[24:27], v[96:103], v9
v_mov_b32_dpp v11, v8 row_newbcast:3 row_mask:0xf bank_mask:0x3
v_mov_b32_dpp v11, v8 row_newbcast:11 row_mask:0xf bank_mask:0xc
v_and_b32 v28, v11, v4
v_and_b32 v29, v11, v5
v_and_b32 v30, v11, v6
v_and_b32 v31, v11, v7
v_smfmac_f32_16x16x64_bf16 v[16:19], v[24:27], v[104:111], v9
s_nop 0
v_smfmac_f32_16x16x64_bf16 v[12:15], v[28:31], v[112:119], v9
v_mov_b32_dpp v11, v8 row_newbcast:4 row_mask:0xf bank_mask:0x3
v_mov_b32_dpp v11, v8 row_newbcast:12 row_mask:0xf bank_mask:0xc
v_and_b32 v24, v11, v4
v_and_b32 v25, v11, v5
v_and_b32 v26, v11, v6
v_and_b32 v27, v11, v7
v_smfmac_f32_16x16x64_bf16 v[16:19], v[28:31], v[120:127], v9
s_nop 0
v_smfmac_f32_16x16x64_bf16 v[12:15], v[24:27], v[128:135], v9
v_mov_b32_dpp v11, v8 row_newbcast:5 row_mask:0xf bank_mask:0x3
v_mov_b32_dpp v11, v8 row_newbcast:13 row_mask:0xf bank_mask:0xc
v_and_b32 v28, v11, v4
v_and_b32 v29, v11, v5
v_and_b32 v30, v11, v6
v_and_b32 v31, v11, v7
v_smfmac_f32_16x16x64_bf16 v[16:19], v[24:27], v[136:143], v9
s_nop 0
v_smfmac_f32_16x16x64_bf16 v[12:15], v[28:31], v[144:151], v9
v_mov_b32_dpp v11, v8 row_newbcast:6 row_mask:0xf bank_mask:0x3
v_mov_b32_dpp v11, v8 row_newbcast:14 row_mask:0xf bank_mask:0xc
v_and_b32 v24, v11, v4
v_and_b32 v25, v11, v5
v_and_b32 v26, v11, v6
v_and_b32 v27, v11, v7
v_smfmac_f32_16x16x64_bf16 v[16:19], v[28:31], v[152:159], v9
s_nop 0
v_smfmac_f32_16x16x64_bf16 v[12:15], v[24:27], v[160:167], v9
v_mov_b32_dpp v11, v8 row_newbcast:7 row_mask:0xf bank_mask:0x3
v_mov_b32_dpp v11, v8 row_newbcast:15 row_mask:0xf bank_mask:0xc
v_and_b32 v28, v11, v4
v_and_b32 v29, v11, v5
v_and_b32 v30, v11, v6
v_and_b32 v31, v11, v7
v_smfmac_f32_16x16x64_bf16 v[16:19], v[24:27], v[168:175], v9
s_nop 0
v_smfmac_f32_16x16x64_bf16 v[12:15], v[28:31], v[176:183], v9
v_smfmac_f32_16x16x64_bf16 v[16:19], v[28:31], v[184:191], v9
s_nop 11
v_permlane32_swap_b32 v12, v16
v_permlane32_swap_b32 v13, v17
v_permlane32_swap_b32 v14, v18
v_permlane32_swap_b32 v15, v19
v_add_f32_dpp v56, v16, v12 row_ror:8 row_mask:0xf bank_mask:0x3
v_add_f32_dpp v57, v17, v13 row_ror:8 row_mask:0xf bank_mask:0x3
v_add_f32_dpp v58, v18, v14 row_ror:8 row_mask:0xf bank_mask:0x3
v_add_f32_dpp v59, v19, v15 row_ror:8 row_mask:0xf bank_mask:0x3
v_fma_f32 v56, v56, v36, v50
global_atomic_add_f32 v40, v39, v56, s[66:67] offset:0 sc0
v_fma_f32 v57, v57, v36, v51
global_atomic_add_f32 v41, v39, v57, s[66:67] offset:256 sc0
v_fma_f32 v58, v58, v36, v52
global_atomic_add_f32 v42, v39, v58, s[66:67] offset:512 sc0
v_fma_f32 v59, v59, v36, v53
global_atomic_add_f32 v43, v39, v59, s[66:67] offset:768 sc0
s_waitcnt vmcnt(3)
v_cmp_eq_u32 s[50:51], s49, v40
v_add_f32 v40, v40, v56
s_waitcnt vmcnt(2)
v_cmp_eq_u32 s[52:53], s49, v41
v_add_f32 v41, v41, v57
v_cvt_pk_bf16_f32 v41, v40, v41
s_lshr_b64 s[50:51], s[50:51], 8
s_waitcnt vmcnt(1)
v_cmp_eq_u32 s[54:55], s49, v42
v_add_f32 v42, v42, v58
s_lshr_b64 s[52:53], s[52:53], 8
s_waitcnt vmcnt(0)
v_cmp_eq_u32 s[58:59], s49, v43
v_add_f32 v43, v43, v59
v_cvt_pk_bf16_f32 v43, v42, v43
s_lshr_b64 s[54:55], s[54:55], 8
s_lshr_b64 s[58:59], s[58:59], 8
s_and_b64 exec, s[50:51], s[46:47]
global_store_short v38, v41, s[60:61] offset:0
s_and_b64 exec, s[52:53], s[46:47]
global_store_short_d16_hi v38, v41, s[60:61] offset:2
s_and_b64 exec, s[54:55], s[46:47]
global_store_short v38, v43, s[60:61] offset:4
s_and_b64 exec, s[58:59], s[46:47]
global_store_short_d16_hi v38, v43, s[60:61] offset:6
s_mov_b32 s48, s50
s_mov_b64 exec, -1
L_donea:
s_or_b32 s62, s3, s30
s_cmp_lg_u32 s62, 0
s_cbranch_scc1 L_fin
s_bitcmp1_b32 s48, 0
s_cbranch_scc0 L_fin
s_mov_b64 exec, 1
v_mov_b32 v3, 0
v_mov_b32 v48, s56
global_store_dword v3, v48, s[28:29]
L_fin:
L_end:
s_endpgm
L_aux23:
s_mov_b64 exec, -1
v_mov_b32 v48, 51744
v_mov_b32 v44, 0
v_mov_b32 v45, 0
v_mov_b32 v46, 0
v_mov_b32 v47, 0
ds_write_b128 v48, v[44:47]
ds_write_b128 v48, v[44:47] offset:16
ds_write_b128 v48, v[44:47] offset:32
v_lshrrev_b32 v10, 4, v0
v_lshrrev_b32 v1, 5, v0
v_lshlrev_b32 v1, 2, v1
v_bfe_u32 v3, v0, 3, 1
v_lshl_add_u32 v1, v3, 1, v1
v_and_b32 v3, 1, v10
v_add_u32 v1, v1, v3
v_mul_u32_u24 v1, 1280, v1
v_and_b32 v3, 7, v0
v_lshl_add_u32 v1, v3, 4, v1
s_mul_i32 s57, s3, 384
s_sub_u32 s57, s57, 256
s_mul_i32 s62, s31, 163840
s_add_u32 s62, s62, s57
s_add_u32 s32, s12, s62
s_addc_u32 s33, s13, 0
s_sub_u32 s34, 163840, s57
s_mov_b32 s35, 0x20000
s_sub_u32 s63, s31, 8
s_cmp_ge_u32 s31, 27
s_cselect_b32 s63, s63, s31
s_mul_i32 s62, s63, 81920
s_add_u32 s62, s62, s57
s_add_u32 s36, s20, s62
s_addc_u32 s37, s21, 0
s_sub_u32 s38, 81920, s57
s_mov_b32 s39, 0x20000
v_bfe_u32 v3, v0, 2, 1
v_cmp_eq_u32 vcc, 0, v3
v_mov_b32 v48, 0xffff
v_mov_b32 v49, 0xffff0000
v_cndmask_b32 v4, 0, v48, vcc
v_cndmask_b32 v6, 0, v49, vcc
v_xor_b32 v5, v4, v48
v_xor_b32 v7, v6, v49
v_and_b32 v9, 3, v0
v_mul_u32_u24 v9, 0x5555, v9
s_waitcnt lgkmcnt(0)
s_barrier
s_setprio 0
s_waitcnt vmcnt(3)
s_mov_b32 s48, 0
buffer_load_dwordx4 v[64:67], v1, s[32:35], s48 offen offset:0 nt
s_waitcnt vmcnt(3)
buffer_load_dwordx4 v[72:75], v1, s[32:35], s48 offen offset:128 nt
s_waitcnt vmcnt(3)
buffer_load_dwordx4 v[80:83], v1, s[32:35], s48 offen offset:256 nt
s_waitcnt vmcnt(3)
s_mov_b32 s48, 10240
buffer_load_dwordx4 v[68:71], v1, s[32:35], s48 offen offset:0 nt
s_waitcnt vmcnt(3)
buffer_load_dwordx4 v[76:79], v1, s[32:35], s48 offen offset:128 nt
s_waitcnt vmcnt(3)
buffer_load_dwordx4 v[84:87], v1, s[32:35], s48 offen offset:256 nt
s_waitcnt vmcnt(3)
s_mov_b32 s48, 20480
buffer_load_dwordx4 v[88:91], v1, s[32:35], s48 offen offset:0 nt
s_waitcnt vmcnt(3)
buffer_load_dwordx4 v[96:99], v1, s[32:35], s48 offen offset:128 nt
s_waitcnt vmcnt(3)
buffer_load_dwordx4 v[104:107], v1, s[32:35], s48 offen offset:256 nt
s_waitcnt vmcnt(3)
s_mov_b32 s48, 30720
buffer_load_dwordx4 v[92:95], v1, s[32:35], s48 offen offset:0 nt
s_waitcnt vmcnt(3)
buffer_load_dwordx4 v[100:103], v1, s[32:35], s48 offen offset:128 nt
s_waitcnt vmcnt(3)
buffer_load_dwordx4 v[108:111], v1, s[32:35], s48 offen offset:256 nt
s_waitcnt vmcnt(3)
s_mov_b32 s48, 40960
buffer_load_dwordx4 v[112:115], v1, s[32:35], s48 offen offset:0 nt
s_waitcnt vmcnt(3)
buffer_load_dwordx4 v[120:123], v1, s[32:35], s48 offen offset:128 nt
s_waitcnt vmcnt(3)
buffer_load_dwordx4 v[128:131], v1, s[32:35], s48 offen offset:256 nt
s_waitcnt vmcnt(3)
s_mov_b32 s48, 51200
buffer_load_dwordx4 v[116:119], v1, s[32:35], s48 offen offset:0 nt
s_waitcnt vmcnt(3)
buffer_load_dwordx4 v[124:127], v1, s[32:35], s48 offen offset:128 nt
s_waitcnt vmcnt(3)
buffer_load_dwordx4 v[132:135], v1, s[32:35], s48 offen offset:256 nt
s_waitcnt vmcnt(3)
s_mov_b32 s48, 0
buffer_load_dwordx4 v[160:163], v1, s[36:39], s48 offen offset:0 nt
s_waitcnt vmcnt(3)
buffer_load_dwordx4 v[168:171], v1, s[36:39], s48 offen offset:128 nt
s_waitcnt vmcnt(3)
buffer_load_dwordx4 v[176:179], v1, s[36:39], s48 offen offset:256 nt
s_waitcnt vmcnt(3)
s_mov_b32 s48, 10240
buffer_load_dwordx4 v[164:167], v1, s[36:39], s48 offen offset:0 nt
s_waitcnt vmcnt(3)
buffer_load_dwordx4 v[172:175], v1, s[36:39], s48 offen offset:128 nt
s_waitcnt vmcnt(3)
buffer_load_dwordx4 v[180:183], v1, s[36:39], s48 offen offset:256 nt
s_waitcnt vmcnt(3)
s_mov_b32 s48, 20480
buffer_load_dwordx4 v[184:187], v1, s[36:39], s48 offen offset:0 nt
s_waitcnt vmcnt(3)
buffer_load_dwordx4 v[192:195], v1, s[36:39], s48 offen offset:128 nt
s_waitcnt vmcnt(3)
buffer_load_dwordx4 v[200:203], v1, s[36:39], s48 offen offset:256 nt
s_waitcnt vmcnt(3)
s_mov_b32 s48, 30720
buffer_load_dwordx4 v[188:191], v1, s[36:39], s48 offen offset:0 nt
s_waitcnt vmcnt(3)
buffer_load_dwordx4 v[196:199], v1, s[36:39], s48 offen offset:128 nt
s_waitcnt vmcnt(3)
buffer_load_dwordx4 v[204:207], v1, s[36:39], s48 offen offset:256 nt
s_waitcnt vmcnt(3)
s_mov_b32 s48, 40960
buffer_load_dwordx4 v[208:211], v1, s[36:39], s48 offen offset:0 nt
s_waitcnt vmcnt(3)
buffer_load_dwordx4 v[216:219], v1, s[36:39], s48 offen offset:128 nt
s_waitcnt vmcnt(3)
buffer_load_dwordx4 v[224:227], v1, s[36:39], s48 offen offset:256 nt
s_waitcnt vmcnt(3)
s_mov_b32 s48, 51200
buffer_load_dwordx4 v[212:215], v1, s[36:39], s48 offen offset:0 nt
s_waitcnt vmcnt(3)
buffer_load_dwordx4 v[220:223], v1, s[36:39], s48 offen offset:128 nt
s_waitcnt vmcnt(3)
buffer_load_dwordx4 v[228:231], v1, s[36:39], s48 offen offset:256 nt
s_waitcnt vmcnt(3)
s_mov_b32 s48, 61440
buffer_load_dwordx4 v[232:235], v1, s[36:39], s48 offen offset:0 nt
s_waitcnt vmcnt(3)
buffer_load_dwordx4 v[240:243], v1, s[36:39], s48 offen offset:128 nt
s_waitcnt vmcnt(3)
buffer_load_dwordx4 v[248:251], v1, s[36:39], s48 offen offset:256 nt
s_waitcnt vmcnt(3)
s_mov_b32 s48, 71680
buffer_load_dwordx4 v[236:239], v1, s[36:39], s48 offen offset:0 nt
s_waitcnt vmcnt(3)
buffer_load_dwordx4 v[244:247], v1, s[36:39], s48 offen offset:128 nt
s_waitcnt vmcnt(3)
buffer_load_dwordx4 v[252:255], v1, s[36:39], s48 offen offset:256 nt
s_waitcnt vmcnt(3)
s_mov_b32 s48, 61440
buffer_load_dwordx4 v[136:139], v1, s[32:35], s48 offen offset:0 nt
s_waitcnt vmcnt(3)
buffer_load_dwordx4 v[144:147], v1, s[32:35], s48 offen offset:128 nt
s_waitcnt vmcnt(3)
buffer_load_dwordx4 v[152:155], v1, s[32:35], s48 offen offset:256 nt
s_waitcnt vmcnt(3)
s_mov_b32 s48, 71680
buffer_load_dwordx4 v[140:143], v1, s[32:35], s48 offen offset:0 nt
s_waitcnt vmcnt(3)
buffer_load_dwordx4 v[148:151], v1, s[32:35], s48 offen offset:128 nt
s_waitcnt vmcnt(3)
buffer_load_dwordx4 v[156:159], v1, s[32:35], s48 offen offset:256 nt
v_mov_b32 v48, 51776
s_mov_b32 s98, 0
L_hwaitb:
ds_read_b32 v51, v48 offset:4
s_waitcnt lgkmcnt(0)
v_cmp_eq_u32 vcc, 0, v51
s_nop 4
s_cbranch_vccz L_hwaitb_ok
s_add_u32 s98, s98, 1
s_cmp_lt_u32 s98, 4194304
s_cbranch_scc1 L_hwaitb
L_hwaitb_ok:
v_and_b32 v48, 3, v0
v_lshlrev_b32 v48, 5, v48
v_lshrrev_b32 v49, 3, v0
v_lshl_add_u32 v48, v49, 2, v48
v_add_u32 v48, 51456, v48
ds_read_b32 v8, v48
v_mov_b32 v48, 51712
ds_read_b64 v[36:37], v48
v_mov_b32 v12, 0
v_mov_b32 v13, 0
v_mov_b32 v14, 0
v_mov_b32 v15, 0
v_mov_b32 v16, 0
v_mov_b32 v17, 0
v_mov_b32 v18, 0
v_mov_b32 v19, 0
v_mov_b32 v20, 0
v_mov_b32 v21, 0
v_mov_b32 v22, 0
v_mov_b32 v23, 0
s_waitcnt vmcnt(3) lgkmcnt(0)
v_mov_b32_dpp v11, v8 row_newbcast:0 row_mask:0xf bank_mask:0x3
v_mov_b32_dpp v11, v8 row_newbcast:8 row_mask:0xf bank_mask:0xc
v_and_b32 v24, v11, v4
v_and_b32 v25, v11, v5
v_and_b32 v26, v11, v6
v_and_b32 v27, v11, v7
s_nop 1
v_smfmac_f32_16x16x64_bf16 v[12:15], v[24:27], v[160:167], v9
v_mov_b32_dpp v11, v8 row_newbcast:1 row_mask:0xf bank_mask:0x3
v_mov_b32_dpp v11, v8 row_newbcast:9 row_mask:0xf bank_mask:0xc
v_and_b32 v28, v11, v4
v_and_b32 v29, v11, v5
v_and_b32 v30, v11, v6
v_and_b32 v31, v11, v7
v_smfmac_f32_16x16x64_bf16 v[16:19], v[24:27], v[168:175], v9
v_smfmac_f32_16x16x64_bf16 v[20:23], v[24:27], v[176:183], v9
v_smfmac_f32_16x16x64_bf16 v[12:15], v[28:31], v[184:191], v9
v_mov_b32_dpp v11, v8 row_newbcast:2 row_mask:0xf bank_mask:0x3
v_mov_b32_dpp v11, v8 row_newbcast:10 row_mask:0xf bank_mask:0xc
v_and_b32 v24, v11, v4
v_and_b32 v25, v11, v5
v_and_b32 v26, v11, v6
v_and_b32 v27, v11, v7
v_smfmac_f32_16x16x64_bf16 v[16:19], v[28:31], v[192:199], v9
v_smfmac_f32_16x16x64_bf16 v[20:23], v[28:31], v[200:207], v9
v_smfmac_f32_16x16x64_bf16 v[12:15], v[24:27], v[208:215], v9
v_mov_b32_dpp v11, v8 row_newbcast:3 row_mask:0xf bank_mask:0x3
v_mov_b32_dpp v11, v8 row_newbcast:11 row_mask:0xf bank_mask:0xc
v_and_b32 v28, v11, v4
v_and_b32 v29, v11, v5
v_and_b32 v30, v11, v6
v_and_b32 v31, v11, v7
v_smfmac_f32_16x16x64_bf16 v[16:19], v[24:27], v[216:223], v9
v_smfmac_f32_16x16x64_bf16 v[20:23], v[24:27], v[224:231], v9
v_smfmac_f32_16x16x64_bf16 v[12:15], v[28:31], v[232:239], v9
v_smfmac_f32_16x16x64_bf16 v[16:19], v[28:31], v[240:247], v9
v_smfmac_f32_16x16x64_bf16 v[20:23], v[28:31], v[248:255], v9
s_waitcnt vmcnt(3)
s_mov_b32 s48, 81920
buffer_load_dwordx4 v[160:163], v1, s[32:35], s48 offen offset:0 nt
s_waitcnt vmcnt(3)
buffer_load_dwordx4 v[168:171], v1, s[32:35], s48 offen offset:128 nt
s_waitcnt vmcnt(3)
buffer_load_dwordx4 v[176:179], v1, s[32:35], s48 offen offset:256 nt
v_mov_b32 v56, 0
v_mov_b32 v57, 0
v_mov_b32 v58, 0
v_mov_b32 v59, 0
v_mov_b32 v60, 0
v_mov_b32 v61, 0
v_permlane32_swap_b32 v12, v16
v_permlane32_swap_b32 v13, v17
v_permlane32_swap_b32 v14, v18
v_permlane32_swap_b32 v15, v19
v_permlane32_swap_b32 v20, v22
v_permlane32_swap_b32 v21, v23
v_add_f32_dpp v56, v16, v12 row_ror:8 row_mask:0xf bank_mask:0x3
v_add_f32_dpp v57, v17, v13 row_ror:8 row_mask:0xf bank_mask:0x3
v_add_f32_dpp v58, v18, v14 row_ror:8 row_mask:0xf bank_mask:0x3
v_add_f32_dpp v59, v19, v15 row_ror:8 row_mask:0xf bank_mask:0x3
v_add_f32_dpp v60, v22, v20 row_ror:8 row_mask:0xf bank_mask:0x3
v_add_f32_dpp v61, v23, v21 row_ror:8 row_mask:0xf bank_mask:0x3
v_bfe_u32 v3, v0, 3, 1
v_cvt_f32_u32 v48, v3
v_cmp_eq_u32 vcc, 0, v3
s_nop 1
v_cndmask_b32 v36, 0, v36, vcc
v_cndmask_b32 v37, 0, v37, vcc
v_fma_f32 v50, v56, v37, v48
v_fma_f32 v51, v57, v37, v48
v_fma_f32 v52, v58, v37, v48
v_fma_f32 v53, v59, v37, v48
v_fma_f32 v54, v60, v37, v48
v_fma_f32 v55, v61, v37, v48
v_mov_b32 v12, 0
v_mov_b32 v13, 0
v_mov_b32 v14, 0
v_mov_b32 v15, 0
v_mov_b32 v16, 0
v_mov_b32 v17, 0
v_mov_b32 v18, 0
v_mov_b32 v19, 0
v_mov_b32 v20, 0
v_mov_b32 v21, 0
v_mov_b32 v22, 0
v_mov_b32 v23, 0
v_and_b32 v2, 7, v0
v_lshlrev_b32 v2, 6, v2
v_lshrrev_b32 v48, 3, v0
v_lshl_add_u32 v2, v48, 3, v2
v_add_u32 v2, 52224, v2
v_lshlrev_b32 v39, 6, v10
v_and_b32 v48, 7, v0
v_lshl_add_u32 v39, v48, 3, v39
v_lshl_add_u32 v39, v3, 2, v39
s_mul_i32 s62, s30, 5120
s_lshl_b32 s63, s57, 2
s_add_u32 s62, s62, s63
s_add_u32 s62, s62, 1052672
s_add_u32 s66, s28, s62
s_addc_u32 s67, s29, 0
v_lshlrev_b32 v48, 4, v48
v_and_b32 v49, 1, v10
v_lshl_add_u32 v48, v49, 3, v48
v_lshrrev_b32 v49, 5, v0
v_lshl_add_u32 v38, v49, 7, v48
v_lshl_add_u32 v37, v49, 2, v48
s_mul_i32 s62, s30, 1280
s_add_u32 s62, s62, s57
s_add_u32 s60, s24, s62
s_addc_u32 s61, s25, 0
s_mov_b32 s46, 0x00ff00ff
s_mov_b32 s47, 0x00ff00ff
s_mov_b32 s49, 0x41f80000
s_lshl_b32 s62, s30, 7
s_add_u32 s62, s62, 1024
v_mov_b32 v48, s62
global_load_dword v49, v48, s[28:29] sc1
s_waitcnt vmcnt(3)
s_mov_b32 s48, 92160
buffer_load_dwordx4 v[164:167], v1, s[32:35], s48 offen offset:0 nt
s_waitcnt vmcnt(3)
buffer_load_dwordx4 v[172:175], v1, s[32:35], s48 offen offset:128 nt
s_waitcnt vmcnt(3)
buffer_load_dwordx4 v[180:183], v1, s[32:35], s48 offen offset:256 nt
s_waitcnt vmcnt(3)
s_mov_b32 s48, 102400
buffer_load_dwordx4 v[184:187], v1, s[32:35], s48 offen offset:0 nt
s_waitcnt vmcnt(3)
buffer_load_dwordx4 v[192:195], v1, s[32:35], s48 offen offset:128 nt
s_waitcnt vmcnt(3)
buffer_load_dwordx4 v[200:203], v1, s[32:35], s48 offen offset:256 nt
s_waitcnt vmcnt(3)
s_mov_b32 s48, 112640
buffer_load_dwordx4 v[188:191], v1, s[32:35], s48 offen offset:0 nt
s_waitcnt vmcnt(3)
buffer_load_dwordx4 v[196:199], v1, s[32:35], s48 offen offset:128 nt
s_waitcnt vmcnt(3)
buffer_load_dwordx4 v[204:207], v1, s[32:35], s48 offen offset:256 nt
s_waitcnt vmcnt(3)
s_mov_b32 s48, 122880
buffer_load_dwordx4 v[208:211], v1, s[32:35], s48 offen offset:0 nt
s_waitcnt vmcnt(3)
buffer_load_dwordx4 v[216:219], v1, s[32:35], s48 offen offset:128 nt
s_waitcnt vmcnt(3)
buffer_load_dwordx4 v[224:227], v1, s[32:35], s48 offen offset:256 nt
s_waitcnt vmcnt(3)
s_mov_b32 s48, 133120
buffer_load_dwordx4 v[212:215], v1, s[32:35], s48 offen offset:0 nt
s_waitcnt vmcnt(3)
buffer_load_dwordx4 v[220:223], v1, s[32:35], s48 offen offset:128 nt
s_waitcnt vmcnt(3)
buffer_load_dwordx4 v[228:231], v1, s[32:35], s48 offen offset:256 nt
s_waitcnt vmcnt(3)
s_mov_b32 s48, 143360
buffer_load_dwordx4 v[232:235], v1, s[32:35], s48 offen offset:0 nt
s_waitcnt vmcnt(3)
buffer_load_dwordx4 v[240:243], v1, s[32:35], s48 offen offset:128 nt
s_waitcnt vmcnt(3)
buffer_load_dwordx4 v[248:251], v1, s[32:35], s48 offen offset:256 nt
s_waitcnt vmcnt(3)
s_mov_b32 s48, 153600
buffer_load_dwordx4 v[236:239], v1, s[32:35], s48 offen offset:0 nt
s_waitcnt vmcnt(3)
buffer_load_dwordx4 v[244:247], v1, s[32:35], s48 offen offset:128 nt
s_waitcnt vmcnt(3)
buffer_load_dwordx4 v[252:255], v1, s[32:35], s48 offen offset:256 nt
s_mov_b32 s98, 0
s_branch L_iwb_in
L_iwb:
global_load_dword v49, v48, s[28:29] sc1
L_iwb_in:
s_waitcnt vmcnt(0) lgkmcnt(0)
v_cmp_ne_u32 vcc, s56, v49
s_nop 4
s_cbranch_vccz L_iwb_ok
s_add_u32 s98, s98, 1
s_cmp_lt_u32 s98, 262144
s_cbranch_scc1 L_iwb
L_iwb_ok:
s_barrier
ds_read_b64 v[40:41], v2 offset:0
ds_read_b64 v[42:43], v2 offset:512
ds_read_b64 v[44:45], v2 offset:1024
ds_read_b64 v[46:47], v2 offset:1536
s_waitcnt lgkmcnt(0)
v_pk_add_f32 v[40:41], v[40:41], v[42:43]
v_pk_add_f32 v[44:45], v[44:45], v[46:47]
v_pk_add_f32 v[40:41], v[40:41], v[44:45]
v_cvt_pk_bf16_f32 v8, v40, v41
s_nop 1
v_mov_b32_dpp v11, v8 row_newbcast:0 row_mask:0xf bank_mask:0x3
v_mov_b32_dpp v11, v8 row_newbcast:8 row_mask:0xf bank_mask:0xc
v_and_b32 v24, v11, v4
v_and_b32 v25, v11, v5
v_and_b32 v26, v11, v6
v_and_b32 v27, v11, v7
s_nop 1
v_smfmac_f32_16x16x64_bf16 v[12:15], v[24:27], v[64:71], v9
v_mov_b32_dpp v11, v8 row_newbcast:1 row_mask:0xf bank_mask:0x3
v_mov_b32_dpp v11, v8 row_newbcast:9 row_mask:0xf bank_mask:0xc
v_and_b32 v28, v11, v4
v_and_b32 v29, v11, v5
v_and_b32 v30, v11, v6
v_and_b32 v31, v11, v7
v_smfmac_f32_16x16x64_bf16 v[16:19], v[24:27], v[72:79], v9
v_smfmac_f32_16x16x64_bf16 v[20:23], v[24:27], v[80:87], v9
v_smfmac_f32_16x16x64_bf16 v[12:15], v[28:31], v[88:95], v9
v_mov_b32_dpp v11, v8 row_newbcast:2 row_mask:0xf bank_mask:0x3
v_mov_b32_dpp v11, v8 row_newbcast:10 row_mask:0xf bank_mask:0xc
v_and_b32 v24, v11, v4
v_and_b32 v25, v11, v5
v_and_b32 v26, v11, v6
v_and_b32 v27, v11, v7
v_smfmac_f32_16x16x64_bf16 v[16:19], v[28:31], v[96:103], v9
v_smfmac_f32_16x16x64_bf16 v[20:23], v[28:31], v[104:111], v9
v_smfmac_f32_16x16x64_bf16 v[12:15], v[24:27], v[112:119], v9
v_mov_b32_dpp v11, v8 row_newbcast:3 row_mask:0xf bank_mask:0x3
v_mov_b32_dpp v11, v8 row_newbcast:11 row_mask:0xf bank_mask:0xc
v_and_b32 v28, v11, v4
v_and_b32 v29, v11, v5
v_and_b32 v30, v11, v6
v_and_b32 v31, v11, v7
v_smfmac_f32_16x16x64_bf16 v[16:19], v[24:27], v[120:127], v9
v_smfmac_f32_16x16x64_bf16 v[20:23], v[24:27], v[128:135], v9
v_smfmac_f32_16x16x64_bf16 v[12:15], v[28:31], v[136:143], v9
v_mov_b32_dpp v11, v8 row_newbcast:4 row_mask:0xf bank_mask:0x3
v_mov_b32_dpp v11, v8 row_newbcast:12 row_mask:0xf bank_mask:0xc
v_and_b32 v24, v11, v4
v_and_b32 v25, v11, v5
v_and_b32 v26, v11, v6
v_and_b32 v27, v11, v7
v_smfmac_f32_16x16x64_bf16 v[16:19], v[28:31], v[144:151], v9
v_smfmac_f32_16x16x64_bf16 v[20:23], v[28:31], v[152:159], v9
v_smfmac_f32_16x16x64_bf16 v[12:15], v[24:27], v[160:167], v9
v_mov_b32_dpp v11, v8 row_newbcast:5 row_mask:0xf bank_mask:0x3
v_mov_b32_dpp v11, v8 row_newbcast:13 row_mask:0xf bank_mask:0xc
v_and_b32 v28, v11, v4
v_and_b32 v29, v11, v5
v_and_b32 v30, v11, v6
v_and_b32 v31, v11, v7
v_smfmac_f32_16x16x64_bf16 v[16:19], v[24:27], v[168:175], v9
v_smfmac_f32_16x16x64_bf16 v[20:23], v[24:27], v[176:183], v9
v_smfmac_f32_16x16x64_bf16 v[12:15], v[28:31], v[184:191], v9
v_mov_b32_dpp v11, v8 row_newbcast:6 row_mask:0xf bank_mask:0x3
v_mov_b32_dpp v11, v8 row_newbcast:14 row_mask:0xf bank_mask:0xc
v_and_b32 v24, v11, v4
v_and_b32 v25, v11, v5
v_and_b32 v26, v11, v6
v_and_b32 v27, v11, v7
v_smfmac_f32_16x16x64_bf16 v[16:19], v[28:31], v[192:199], v9
v_smfmac_f32_16x16x64_bf16 v[20:23], v[28:31], v[200:207], v9
v_smfmac_f32_16x16x64_bf16 v[12:15], v[24:27], v[208:215], v9
v_mov_b32_dpp v11, v8 row_newbcast:7 row_mask:0xf bank_mask:0x3
v_mov_b32_dpp v11, v8 row_newbcast:15 row_mask:0xf bank_mask:0xc
v_and_b32 v28, v11, v4
v_and_b32 v29, v11, v5
v_and_b32 v30, v11, v6
v_and_b32 v31, v11, v7
v_smfmac_f32_16x16x64_bf16 v[16:19], v[24:27], v[216:223], v9
v_smfmac_f32_16x16x64_bf16 v[20:23], v[24:27], v[224:231], v9
v_smfmac_f32_16x16x64_bf16 v[12:15], v[28:31], v[232:239], v9
v_smfmac_f32_16x16x64_bf16 v[16:19], v[28:31], v[240:247], v9
v_smfmac_f32_16x16x64_bf16 v[20:23], v[28:31], v[248:255], v9
s_nop 10
v_permlane32_swap_b32 v12, v16
v_permlane32_swap_b32 v13, v17
v_permlane32_swap_b32 v14, v18
v_permlane32_swap_b32 v15, v19
v_permlane32_swap_b32 v20, v22
v_permlane32_swap_b32 v21, v23
v_add_f32_dpp v56, v16, v12 row_ror:8 row_mask:0xf bank_mask:0x3
v_add_f32_dpp v57, v17, v13 row_ror:8 row_mask:0xf bank_mask:0x3
v_add_f32_dpp v58, v18, v14 row_ror:8 row_mask:0xf bank_mask:0x3
v_add_f32_dpp v59, v19, v15 row_ror:8 row_mask:0xf bank_mask:0x3
v_add_f32_dpp v60, v22, v20 row_ror:8 row_mask:0xf bank_mask:0x3
v_add_f32_dpp v61, v23, v21 row_ror:8 row_mask:0xf bank_mask:0x3
v_fma_f32 v56, v56, v36, v50
global_atomic_add_f32 v40, v39, v56, s[66:67] offset:0 sc0
v_fma_f32 v57, v57, v36, v51
global_atomic_add_f32 v41, v39, v57, s[66:67] offset:256 sc0
v_fma_f32 v58, v58, v36, v52
global_atomic_add_f32 v42, v39, v58, s[66:67] offset:512 sc0
v_fma_f32 v59, v59, v36, v53
global_atomic_add_f32 v43, v39, v59, s[66:67] offset:768 sc0
v_fma_f32 v60, v60, v36, v54
global_atomic_add_f32 v44, v39, v60, s[66:67] offset:1024 sc0
v_fma_f32 v61, v61, v36, v55
global_atomic_add_f32 v45, v39, v61, s[66:67] offset:1280 sc0
s_waitcnt vmcnt(5)
v_cmp_eq_u32 s[50:51], s49, v40
v_add_f32 v40, v40, v56
s_waitcnt vmcnt(4)
v_cmp_eq_u32 s[52:53], s49, v41
v_add_f32 v41, v41, v57
v_cvt_pk_bf16_f32 v41, v40, v41
s_lshr_b64 s[50:51], s[50:51], 8
s_waitcnt vmcnt(3)
v_cmp_eq_u32 s[54:55], s49, v42
v_add_f32 v42, v42, v58
s_lshr_b64 s[52:53], s[52:53], 8
s_waitcnt vmcnt(2)
v_cmp_eq_u32 s[58:59], s49, v43
v_add_f32 v43, v43, v59
v_cvt_pk_bf16_f32 v43, v42, v43
s_lshr_b64 s[54:55], s[54:55], 8
s_waitcnt vmcnt(1)
v_cmp_eq_u32 s[62:63], s49, v44
v_add_f32 v44, v44, v60
s_lshr_b64 s[58:59], s[58:59], 8
s_waitcnt vmcnt(0)
v_cmp_eq_u32 s[64:65], s49, v45
v_add_f32 v45, v45, v61
v_cvt_pk_bf16_f32 v45, v44, v45
s_lshr_b64 s[62:63], s[62:63], 8
s_lshr_b64 s[64:65], s[64:65], 8
s_and_b64 exec, s[50:51], s[46:47]
global_store_short v38, v41, s[60:61] offset:0
s_and_b64 exec, s[52:53], s[46:47]
global_store_short_d16_hi v38, v41, s[60:61] offset:2
s_and_b64 exec, s[54:55], s[46:47]
global_store_short v38, v43, s[60:61] offset:4
s_and_b64 exec, s[58:59], s[46:47]
global_store_short_d16_hi v38, v43, s[60:61] offset:6
s_and_b64 exec, s[62:63], s[46:47]
global_store_short v37, v45, s[60:61] offset:256
s_and_b64 exec, s[64:65], s[46:47]
global_store_short_d16_hi v37, v45, s[60:61] offset:258
s_mov_b64 exec, -1
L_doneb:
s_endpgm
L_stream:
s_sub_u32 s57, s3, 4
v_and_b32 v3, 3, v0
v_lshlrev_b32 v1, 4, v3
v_bfe_u32 v3, v0, 2, 2
v_lshl_add_u32 v1, v3, 8, v1
v_lshrrev_b32 v3, 4, v0
v_lshl_add_u32 v1, v3, 6, v1
s_lshl_b32 s56, s2, 20
s_add_u32 s56, s56, 0xC0000
s_mul_i32 s41, s57, 8192
s_mov_b32 s34, 0x40000
s_mov_b32 s35, 0x20000
s_mov_b32 s38, 0x40000
s_mov_b32 s39, 0x20000
s_waitcnt lgkmcnt(0)
s_add_u32 s32, s6, s56
s_addc_u32 s33, s7, 0
s_add_u32 s36, s8, s56
s_addc_u32 s37, s9, 0
s_xor_b32 s40, s41, 0
buffer_load_dwordx4 v[56:59], v1, s[32:35], s40 offen offset:0 nt
buffer_load_dwordx4 v[60:63], v1, s[32:35], s40 offen offset:1024 nt
buffer_load_dwordx4 v[64:67], v1, s[32:35], s40 offen offset:2048 nt
v_lshlrev_b32 v2, 4, v0
v_and_b32 v51, 1, v0
v_lshlrev_b32 v51, 4, v51
v_mov_b32 v48, 0xffff
v_lshlrev_b32 v48, v51, v48
v_bfe_u32 v51, v0, 1, 3
v_cmp_eq_u32 vcc, 0, v51
s_nop 1
v_cndmask_b32 v4, 0, v48, vcc
v_cmp_eq_u32 vcc, 1, v51
s_nop 1
v_cndmask_b32 v5, 0, v48, vcc
v_cmp_eq_u32 vcc, 2, v51
s_nop 1
v_cndmask_b32 v6, 0, v48, vcc
v_cmp_eq_u32 vcc, 3, v51
s_nop 1
v_cndmask_b32 v7, 0, v48, vcc
v_lshrrev_b32 v49, 2, v0
v_lshlrev_b32 v49, 4, v49
v_add_u32 v49, 51200, v49
v_and_b32 v50, 3, v0
s_barrier
buffer_load_dwordx4 v[68:71], v1, s[32:35], s40 offen offset:3072 nt
s_xor_b32 s40, s41, 4096
buffer_load_dwordx4 v[72:75], v1, s[32:35], s40 offen offset:0 nt
buffer_load_dwordx4 v[76:79], v1, s[32:35], s40 offen offset:1024 nt
s_waitcnt vmcnt(5)
buffer_load_dwordx4 v[80:83], v1, s[32:35], s40 offen offset:2048 nt
s_waitcnt vmcnt(5)
buffer_load_dwordx4 v[84:87], v1, s[32:35], s40 offen offset:3072 nt
s_waitcnt vmcnt(5)
s_xor_b32 s40, s41, 32768
buffer_load_dwordx4 v[88:91], v1, s[32:35], s40 offen offset:0 nt
s_waitcnt vmcnt(5)
buffer_load_dwordx4 v[92:95], v1, s[32:35], s40 offen offset:1024 nt
s_waitcnt vmcnt(5)
buffer_load_dwordx4 v[96:99], v1, s[32:35], s40 offen offset:2048 nt
s_waitcnt vmcnt(5)
buffer_load_dwordx4 v[100:103], v1, s[32:35], s40 offen offset:3072 nt
s_waitcnt vmcnt(5)
s_xor_b32 s40, s41, 36864
buffer_load_dwordx4 v[104:107], v1, s[32:35], s40 offen offset:0 nt
s_waitcnt vmcnt(5)
buffer_load_dwordx4 v[108:111], v1, s[32:35], s40 offen offset:1024 nt
s_waitcnt vmcnt(5)
buffer_load_dwordx4 v[112:115], v1, s[32:35], s40 offen offset:2048 nt
s_waitcnt vmcnt(5)
buffer_load_dwordx4 v[116:119], v1, s[32:35], s40 offen offset:3072 nt
s_waitcnt vmcnt(5)
s_xor_b32 s40, s41, 65536
buffer_load_dwordx4 v[120:123], v1, s[32:35], s40 offen offset:0 nt
s_waitcnt vmcnt(5)
buffer_load_dwordx4 v[124:127], v1, s[32:35], s40 offen offset:1024 nt
s_waitcnt vmcnt(5)
buffer_load_dwordx4 v[128:131], v1, s[32:35], s40 offen offset:2048 nt
s_waitcnt vmcnt(5)
buffer_load_dwordx4 v[132:135], v1, s[32:35], s40 offen offset:3072 nt
s_waitcnt vmcnt(5)
s_xor_b32 s40, s41, 69632
buffer_load_dwordx4 v[136:139], v1, s[32:35], s40 offen offset:0 nt
s_waitcnt vmcnt(5)
buffer_load_dwordx4 v[140:143], v1, s[32:35], s40 offen offset:1024 nt
s_waitcnt vmcnt(5)
buffer_load_dwordx4 v[144:147], v1, s[32:35], s40 offen offset:2048 nt
s_waitcnt vmcnt(5)
buffer_load_dwordx4 v[148:151], v1, s[32:35], s40 offen offset:3072 nt
s_waitcnt vmcnt(5)
s_xor_b32 s40, s41, 98304
buffer_load_dwordx4 v[152:155], v1, s[32:35], s40 offen offset:0 nt
s_waitcnt vmcnt(5)
buffer_load_dwordx4 v[156:159], v1, s[32:35], s40 offen offset:1024 nt
s_waitcnt vmcnt(5)
buffer_load_dwordx4 v[160:163], v1, s[32:35], s40 offen offset:2048 nt
s_waitcnt vmcnt(5)
buffer_load_dwordx4 v[164:167], v1, s[32:35], s40 offen offset:3072 nt
s_waitcnt vmcnt(5)
s_xor_b32 s40, s41, 102400
buffer_load_dwordx4 v[168:171], v1, s[32:35], s40 offen offset:0 nt
s_waitcnt vmcnt(5)
buffer_load_dwordx4 v[172:175], v1, s[32:35], s40 offen offset:1024 nt
s_waitcnt vmcnt(5)
buffer_load_dwordx4 v[176:179], v1, s[32:35], s40 offen offset:2048 nt
s_waitcnt vmcnt(5)
buffer_load_dwordx4 v[180:183], v1, s[32:35], s40 offen offset:3072 nt
s_waitcnt vmcnt(5)
s_xor_b32 s40, s41, 131072
buffer_load_dwordx4 v[184:187], v1, s[32:35], s40 offen offset:0 nt
s_waitcnt vmcnt(5)
buffer_load_dwordx4 v[188:191], v1, s[32:35], s40 offen offset:1024 nt
s_waitcnt vmcnt(5)
buffer_load_dwordx4 v[192:195], v1, s[32:35], s40 offen offset:2048 nt
s_waitcnt vmcnt(5)
buffer_load_dwordx4 v[196:199], v1, s[32:35], s40 offen offset:3072 nt
s_waitcnt vmcnt(5)
s_xor_b32 s40, s41, 135168
buffer_load_dwordx4 v[200:203], v1, s[32:35], s40 offen offset:0 nt
s_waitcnt vmcnt(5)
buffer_load_dwordx4 v[204:207], v1, s[32:35], s40 offen offset:1024 nt
s_waitcnt vmcnt(5)
buffer_load_dwordx4 v[208:211], v1, s[32:35], s40 offen offset:2048 nt
s_waitcnt vmcnt(5)
buffer_load_dwordx4 v[212:215], v1, s[32:35], s40 offen offset:3072 nt
s_waitcnt vmcnt(5)
s_xor_b32 s40, s41, 163840
buffer_load_dwordx4 v[216:219], v1, s[32:35], s40 offen offset:0 nt
s_waitcnt vmcnt(5)
buffer_load_dwordx4 v[220:223], v1, s[32:35], s40 offen offset:1024 nt
s_waitcnt vmcnt(5)
buffer_load_dwordx4 v[224:227], v1, s[32:35], s40 offen offset:2048 nt
s_waitcnt vmcnt(5)
buffer_load_dwordx4 v[228:231], v1, s[32:35], s40 offen offset:3072 nt
s_waitcnt vmcnt(5)
s_xor_b32 s40, s41, 167936
buffer_load_dwordx4 v[232:235], v1, s[32:35], s40 offen offset:0 nt
s_waitcnt vmcnt(5)
buffer_load_dwordx4 v[236:239], v1, s[32:35], s40 offen offset:1024 nt
s_waitcnt vmcnt(5)
buffer_load_dwordx4 v[240:243], v1, s[32:35], s40 offen offset:2048 nt
s_waitcnt vmcnt(5)
buffer_load_dwordx4 v[244:247], v1, s[32:35], s40 offen offset:3072 nt
s_waitcnt vmcnt(5)
s_xor_b32 s40, s41, 196608
buffer_load_dwordx4 v[248:251], v1, s[32:35], s40 offen offset:0 nt
s_waitcnt vmcnt(5)
buffer_load_dwordx4 v[252:255], v1, s[32:35], s40 offen offset:1024 nt
v_mov_b32 v48, 51776
s_mov_b32 s98, 0
L_qwait:
ds_read_b32 v51, v48 offset:0
s_waitcnt lgkmcnt(0)
v_cmp_eq_u32 vcc, 0, v51
s_nop 4
s_cbranch_vccz L_qwait_ok
s_add_u32 s98, s98, 1
s_cmp_lt_u32 s98, 4194304
s_cbranch_scc1 L_qwait
L_qwait_ok:
ds_read_b128 v[52:55], v49
s_waitcnt lgkmcnt(0)
v_cmp_eq_u32 vcc, 0, v50
s_nop 1
v_cndmask_b32 v12, 0, v52, vcc
v_cndmask_b32 v13, 0, v53, vcc
v_cndmask_b32 v14, 0, v54, vcc
v_cndmask_b32 v15, 0, v55, vcc
v_cmp_eq_u32 vcc, 1, v50
s_nop 1
v_cndmask_b32 v16, 0, v52, vcc
v_cndmask_b32 v17, 0, v53, vcc
v_cndmask_b32 v18, 0, v54, vcc
v_cndmask_b32 v19, 0, v55, vcc
v_cmp_eq_u32 vcc, 2, v50
s_nop 1
v_cndmask_b32 v20, 0, v52, vcc
v_cndmask_b32 v21, 0, v53, vcc
v_cndmask_b32 v22, 0, v54, vcc
v_cndmask_b32 v23, 0, v55, vcc
v_cmp_eq_u32 vcc, 3, v50
s_nop 1
v_cndmask_b32 v24, 0, v52, vcc
v_cndmask_b32 v25, 0, v53, vcc
v_cndmask_b32 v26, 0, v54, vcc
v_cndmask_b32 v27, 0, v55, vcc
v_mfma_f32_16x16x32_bf16 v[28:31], v[56:59], v[12:15], 0
v_mfma_f32_16x16x32_bf16 v[28:31], v[60:63], v[16:19], v[28:31]
v_mfma_f32_16x16x32_bf16 v[28:31], v[64:67], v[20:23], v[28:31]
v_mfma_f32_16x16x32_bf16 v[28:31], v[68:71], v[24:27], v[28:31]
v_mfma_f32_16x16x32_bf16 v[32:35], v[72:75], v[12:15], 0
v_mfma_f32_16x16x32_bf16 v[32:35], v[76:79], v[16:19], v[32:35]
v_mfma_f32_16x16x32_bf16 v[32:35], v[80:83], v[20:23], v[32:35]
v_mfma_f32_16x16x32_bf16 v[32:35], v[84:87], v[24:27], v[32:35]
s_nop 3
v_mov_b32_dpp v8, v28 quad_perm:[0,1,2,3] row_mask:0xf bank_mask:1
v_add_f32_dpp v8, v29, v8 row_ror:12 row_mask:0xf bank_mask:1
v_add_f32_dpp v8, v30, v8 row_ror:8 row_mask:0xf bank_mask:1
v_add_f32_dpp v8, v31, v8 row_ror:4 row_mask:0xf bank_mask:1
s_waitcnt vmcnt(5)
buffer_load_dwordx4 v[56:59], v1, s[32:35], s40 offen offset:2048 nt
s_waitcnt vmcnt(5)
buffer_load_dwordx4 v[60:63], v1, s[32:35], s40 offen offset:3072 nt
s_waitcnt vmcnt(5)
s_xor_b32 s40, s41, 200704
buffer_load_dwordx4 v[64:67], v1, s[32:35], s40 offen offset:0 nt
s_waitcnt vmcnt(5)
buffer_load_dwordx4 v[68:71], v1, s[32:35], s40 offen offset:1024 nt
s_waitcnt vmcnt(5)
buffer_load_dwordx4 v[72:75], v1, s[32:35], s40 offen offset:2048 nt
s_waitcnt vmcnt(5)
buffer_load_dwordx4 v[76:79], v1, s[32:35], s40 offen offset:3072 nt
v_mfma_f32_16x16x32_bf16 v[28:31], v[88:91], v[12:15], 0
v_mfma_f32_16x16x32_bf16 v[28:31], v[92:95], v[16:19], v[28:31]
v_mfma_f32_16x16x32_bf16 v[28:31], v[96:99], v[20:23], v[28:31]
v_mfma_f32_16x16x32_bf16 v[28:31], v[100:103], v[24:27], v[28:31]
v_mov_b32_dpp v8, v32 row_ror:4 row_mask:0xf bank_mask:2
v_add_f32_dpp v8, v33, v8 quad_perm:[0,1,2,3] row_mask:0xf bank_mask:2
v_add_f32_dpp v8, v34, v8 row_ror:12 row_mask:0xf bank_mask:2
v_add_f32_dpp v8, v35, v8 row_ror:8 row_mask:0xf bank_mask:2
v_mfma_f32_16x16x32_bf16 v[32:35], v[104:107], v[12:15], 0
v_mfma_f32_16x16x32_bf16 v[32:35], v[108:111], v[16:19], v[32:35]
v_mfma_f32_16x16x32_bf16 v[32:35], v[112:115], v[20:23], v[32:35]
v_mfma_f32_16x16x32_bf16 v[32:35], v[116:119], v[24:27], v[32:35]
v_mov_b32_dpp v8, v28 row_ror:8 row_mask:0xf bank_mask:4
v_add_f32_dpp v8, v29, v8 row_ror:4 row_mask:0xf bank_mask:4
v_add_f32_dpp v8, v30, v8 quad_perm:[0,1,2,3] row_mask:0xf bank_mask:4
v_add_f32_dpp v8, v31, v8 row_ror:12 row_mask:0xf bank_mask:4
s_waitcnt vmcnt(5)
s_xor_b32 s40, s41, 229376
buffer_load_dwordx4 v[80:83], v1, s[32:35], s40 offen offset:0 nt
v_mfma_f32_16x16x32_bf16 v[28:31], v[120:123], v[12:15], 0
v_mfma_f32_16x16x32_bf16 v[28:31], v[124:127], v[16:19], v[28:31]
v_mfma_f32_16x16x32_bf16 v[28:31], v[128:131], v[20:23], v[28:31]
v_mfma_f32_16x16x32_bf16 v[28:31], v[132:135], v[24:27], v[28:31]
v_mov_b32_dpp v8, v32 row_ror:12 row_mask:0xf bank_mask:8
v_add_f32_dpp v8, v33, v8 row_ror:8 row_mask:0xf bank_mask:8
v_add_f32_dpp v8, v34, v8 row_ror:4 row_mask:0xf bank_mask:8
v_add_f32_dpp v8, v35, v8 quad_perm:[0,1,2,3] row_mask:0xf bank_mask:8
v_mfma_f32_16x16x32_bf16 v[32:35], v[136:139], v[12:15], 0
v_mfma_f32_16x16x32_bf16 v[32:35], v[140:143], v[16:19], v[32:35]
v_mfma_f32_16x16x32_bf16 v[32:35], v[144:147], v[20:23], v[32:35]
v_mfma_f32_16x16x32_bf16 v[32:35], v[148:151], v[24:27], v[32:35]
v_mov_b32_dpp v9, v28 quad_perm:[0,1,2,3] row_mask:0xf bank_mask:1
v_add_f32_dpp v9, v29, v9 row_ror:12 row_mask:0xf bank_mask:1
v_add_f32_dpp v9, v30, v9 row_ror:8 row_mask:0xf bank_mask:1
v_add_f32_dpp v9, v31, v9 row_ror:4 row_mask:0xf bank_mask:1
s_waitcnt vmcnt(5)
buffer_load_dwordx4 v[84:87], v1, s[32:35], s40 offen offset:1024 nt
v_mfma_f32_16x16x32_bf16 v[28:31], v[152:155], v[12:15], 0
v_mfma_f32_16x16x32_bf16 v[28:31], v[156:159], v[16:19], v[28:31]
v_mfma_f32_16x16x32_bf16 v[28:31], v[160:163], v[20:23], v[28:31]
v_mfma_f32_16x16x32_bf16 v[28:31], v[164:167], v[24:27], v[28:31]
v_mov_b32_dpp v9, v32 row_ror:4 row_mask:0xf bank_mask:2
v_add_f32_dpp v9, v33, v9 quad_perm:[0,1,2,3] row_mask:0xf bank_mask:2
v_add_f32_dpp v9, v34, v9 row_ror:12 row_mask:0xf bank_mask:2
v_add_f32_dpp v9, v35, v9 row_ror:8 row_mask:0xf bank_mask:2
v_mfma_f32_16x16x32_bf16 v[32:35], v[168:171], v[12:15], 0
v_mfma_f32_16x16x32_bf16 v[32:35], v[172:175], v[16:19], v[32:35]
v_mfma_f32_16x16x32_bf16 v[32:35], v[176:179], v[20:23], v[32:35]
v_mfma_f32_16x16x32_bf16 v[32:35], v[180:183], v[24:27], v[32:35]
v_mov_b32_dpp v9, v28 row_ror:8 row_mask:0xf bank_mask:4
v_add_f32_dpp v9, v29, v9 row_ror:4 row_mask:0xf bank_mask:4
v_add_f32_dpp v9, v30, v9 quad_perm:[0,1,2,3] row_mask:0xf bank_mask:4
v_add_f32_dpp v9, v31, v9 row_ror:12 row_mask:0xf bank_mask:4
s_waitcnt vmcnt(5)
buffer_load_dwordx4 v[88:91], v1, s[32:35], s40 offen offset:2048 nt
v_mfma_f32_16x16x32_bf16 v[28:31], v[184:187], v[12:15], 0
v_mfma_f32_16x16x32_bf16 v[28:31], v[188:191], v[16:19], v[28:31]
v_mfma_f32_16x16x32_bf16 v[28:31], v[192:195], v[20:23], v[28:31]
v_mfma_f32_16x16x32_bf16 v[28:31], v[196:199], v[24:27], v[28:31]
v_mov_b32_dpp v9, v32 row_ror:12 row_mask:0xf bank_mask:8
v_add_f32_dpp v9, v33, v9 row_ror:8 row_mask:0xf bank_mask:8
v_add_f32_dpp v9, v34, v9 row_ror:4 row_mask:0xf bank_mask:8
v_add_f32_dpp v9, v35, v9 quad_perm:[0,1,2,3] row_mask:0xf bank_mask:8
v_mfma_f32_16x16x32_bf16 v[32:35], v[200:203], v[12:15], 0
v_mfma_f32_16x16x32_bf16 v[32:35], v[204:207], v[16:19], v[32:35]
v_mfma_f32_16x16x32_bf16 v[32:35], v[208:211], v[20:23], v[32:35]
v_mfma_f32_16x16x32_bf16 v[32:35], v[212:215], v[24:27], v[32:35]
v_mov_b32_dpp v10, v28 quad_perm:[0,1,2,3] row_mask:0xf bank_mask:1
v_add_f32_dpp v10, v29, v10 row_ror:12 row_mask:0xf bank_mask:1
v_add_f32_dpp v10, v30, v10 row_ror:8 row_mask:0xf bank_mask:1
v_add_f32_dpp v10, v31, v10 row_ror:4 row_mask:0xf bank_mask:1
s_waitcnt vmcnt(5)
buffer_load_dwordx4 v[92:95], v1, s[32:35], s40 offen offset:3072 nt
v_mfma_f32_16x16x32_bf16 v[28:31], v[216:219], v[12:15], 0
v_mfma_f32_16x16x32_bf16 v[28:31], v[220:223], v[16:19], v[28:31]
v_mfma_f32_16x16x32_bf16 v[28:31], v[224:227], v[20:23], v[28:31]
v_mfma_f32_16x16x32_bf16 v[28:31], v[228:231], v[24:27], v[28:31]
v_mov_b32_dpp v10, v32 row_ror:4 row_mask:0xf bank_mask:2
v_add_f32_dpp v10, v33, v10 quad_perm:[0,1,2,3] row_mask:0xf bank_mask:2
v_add_f32_dpp v10, v34, v10 row_ror:12 row_mask:0xf bank_mask:2
v_add_f32_dpp v10, v35, v10 row_ror:8 row_mask:0xf bank_mask:2
v_mfma_f32_16x16x32_bf16 v[32:35], v[232:235], v[12:15], 0
v_mfma_f32_16x16x32_bf16 v[32:35], v[236:239], v[16:19], v[32:35]
v_mfma_f32_16x16x32_bf16 v[32:35], v[240:243], v[20:23], v[32:35]
v_mfma_f32_16x16x32_bf16 v[32:35], v[244:247], v[24:27], v[32:35]
v_mov_b32_dpp v10, v28 row_ror:8 row_mask:0xf bank_mask:4
v_add_f32_dpp v10, v29, v10 row_ror:4 row_mask:0xf bank_mask:4
v_add_f32_dpp v10, v30, v10 quad_perm:[0,1,2,3] row_mask:0xf bank_mask:4
v_add_f32_dpp v10, v31, v10 row_ror:12 row_mask:0xf bank_mask:4
s_waitcnt vmcnt(5)
s_xor_b32 s40, s41, 233472
buffer_load_dwordx4 v[96:99], v1, s[32:35], s40 offen offset:0 nt
v_mfma_f32_16x16x32_bf16 v[28:31], v[248:251], v[12:15], 0
v_mfma_f32_16x16x32_bf16 v[28:31], v[252:255], v[16:19], v[28:31]
v_mfma_f32_16x16x32_bf16 v[28:31], v[56:59], v[20:23], v[28:31]
v_mfma_f32_16x16x32_bf16 v[28:31], v[60:63], v[24:27], v[28:31]
v_mov_b32_dpp v10, v32 row_ror:12 row_mask:0xf bank_mask:8
v_add_f32_dpp v10, v33, v10 row_ror:8 row_mask:0xf bank_mask:8
v_add_f32_dpp v10, v34, v10 row_ror:4 row_mask:0xf bank_mask:8
v_add_f32_dpp v10, v35, v10 quad_perm:[0,1,2,3] row_mask:0xf bank_mask:8
s_waitcnt vmcnt(5)
buffer_load_dwordx4 v[100:103], v1, s[32:35], s40 offen offset:1024 nt
v_mfma_f32_16x16x32_bf16 v[32:35], v[64:67], v[12:15], 0
v_mfma_f32_16x16x32_bf16 v[32:35], v[68:71], v[16:19], v[32:35]
v_mfma_f32_16x16x32_bf16 v[32:35], v[72:75], v[20:23], v[32:35]
v_mfma_f32_16x16x32_bf16 v[32:35], v[76:79], v[24:27], v[32:35]
v_mov_b32_dpp v11, v28 quad_perm:[0,1,2,3] row_mask:0xf bank_mask:1
v_add_f32_dpp v11, v29, v11 row_ror:12 row_mask:0xf bank_mask:1
v_add_f32_dpp v11, v30, v11 row_ror:8 row_mask:0xf bank_mask:1
v_add_f32_dpp v11, v31, v11 row_ror:4 row_mask:0xf bank_mask:1
s_waitcnt vmcnt(5)
buffer_load_dwordx4 v[104:107], v1, s[32:35], s40 offen offset:2048 nt
s_waitcnt vmcnt(5)
buffer_load_dwordx4 v[108:111], v1, s[32:35], s40 offen offset:3072 nt
s_waitcnt vmcnt(5)
s_xor_b32 s40, s41, 0
buffer_load_dwordx4 v[112:115], v2, s[36:39], s40 offen offset:0 nt
s_waitcnt vmcnt(5)
buffer_load_dwordx4 v[116:119], v2, s[36:39], s40 offen offset:1024 nt
v_mfma_f32_16x16x32_bf16 v[28:31], v[80:83], v[12:15], 0
v_mfma_f32_16x16x32_bf16 v[28:31], v[84:87], v[16:19], v[28:31]
v_mfma_f32_16x16x32_bf16 v[28:31], v[88:91], v[20:23], v[28:31]
v_mfma_f32_16x16x32_bf16 v[28:31], v[92:95], v[24:27], v[28:31]
v_mov_b32_dpp v11, v32 row_ror:4 row_mask:0xf bank_mask:2
v_add_f32_dpp v11, v33, v11 quad_perm:[0,1,2,3] row_mask:0xf bank_mask:2
v_add_f32_dpp v11, v34, v11 row_ror:12 row_mask:0xf bank_mask:2
v_add_f32_dpp v11, v35, v11 row_ror:8 row_mask:0xf bank_mask:2
s_waitcnt vmcnt(5)
buffer_load_dwordx4 v[120:123], v2, s[36:39], s40 offen offset:2048 nt
s_waitcnt vmcnt(5)
buffer_load_dwordx4 v[124:127], v2, s[36:39], s40 offen offset:3072 nt
s_waitcnt vmcnt(5)
s_xor_b32 s40, s41, 4096
buffer_load_dwordx4 v[128:131], v2, s[36:39], s40 offen offset:0 nt
s_waitcnt vmcnt(5)
buffer_load_dwordx4 v[132:135], v2, s[36:39], s40 offen offset:1024 nt
v_mfma_f32_16x16x32_bf16 v[32:35], v[96:99], v[12:15], 0
v_mfma_f32_16x16x32_bf16 v[32:35], v[100:103], v[16:19], v[32:35]
v_mfma_f32_16x16x32_bf16 v[32:35], v[104:107], v[20:23], v[32:35]
v_mfma_f32_16x16x32_bf16 v[32:35], v[108:111], v[24:27], v[32:35]
v_mov_b32_dpp v11, v28 row_ror:8 row_mask:0xf bank_mask:4
v_add_f32_dpp v11, v29, v11 row_ror:4 row_mask:0xf bank_mask:4
v_add_f32_dpp v11, v30, v11 quad_perm:[0,1,2,3] row_mask:0xf bank_mask:4
v_add_f32_dpp v11, v31, v11 row_ror:12 row_mask:0xf bank_mask:4
s_nop 3
v_mov_b32_dpp v11, v32 row_ror:12 row_mask:0xf bank_mask:8
v_add_f32_dpp v11, v33, v11 row_ror:8 row_mask:0xf bank_mask:8
v_add_f32_dpp v11, v34, v11 row_ror:4 row_mask:0xf bank_mask:8
v_add_f32_dpp v11, v35, v11 quad_perm:[0,1,2,3] row_mask:0xf bank_mask:8
s_mov_b32 s58, 1035273459
s_mov_b32 s59, 1069066811
v_cvt_pk_bf16_f32 v48, v8, v9
v_cvt_pk_bf16_f32 v49, v10, v11
v_lshlrev_b32 v8, 16, v48
v_and_b32 v9, 0xffff0000, v48
v_lshlrev_b32 v10, 16, v49
v_and_b32 v11, 0xffff0000, v49
v_mul_f32 v8, s58, v8
v_mul_f32 v9, s58, v9
v_mul_f32 v10, s58, v10
v_mul_f32 v11, s58, v11
v_cvt_pk_bf16_f32 v48, v8, v9
v_cvt_pk_bf16_f32 v49, v10, v11
v_lshlrev_b32 v8, 16, v48
v_and_b32 v9, 0xffff0000, v48
v_lshlrev_b32 v10, 16, v49
v_and_b32 v11, 0xffff0000, v49
v_max3_f32 v50, v8, v9, v10
v_max_f32 v50, v50, v11
s_nop 1
v_max_f32_dpp v50, v50, v50 row_ror:1 row_mask:0xf bank_mask:0xf
s_nop 1
v_max_f32_dpp v50, v50, v50 row_ror:2 row_mask:0xf bank_mask:0xf
s_nop 1
v_max_f32_dpp v50, v50, v50 row_ror:4 row_mask:0xf bank_mask:0xf
s_nop 1
v_max_f32_dpp v50, v50, v50 row_ror:8 row_mask:0xf bank_mask:0xf
v_mov_b32 v48, v50
s_nop 1
v_permlane16_swap_b32 v50, v48
v_max_f32 v50, v50, v48
v_mov_b32 v48, v50
s_nop 1
v_permlane32_swap_b32 v50, v48
v_max_f32 v50, v50, v48
v_sub_f32 v8, v8, v50
v_sub_f32 v9, v9, v50
v_sub_f32 v10, v10, v50
v_sub_f32 v11, v11, v50
v_mul_f32 v8, s59, v8
v_mul_f32 v9, s59, v9
v_mul_f32 v10, s59, v10
v_mul_f32 v11, s59, v11
v_exp_f32 v8, v8
v_exp_f32 v9, v9
v_exp_f32 v10, v10
v_exp_f32 v11, v11
v_add_f32 v51, v8, v9
v_add_f32 v48, v10, v11
v_add_f32 v51, v51, v48
v_cvt_pk_bf16_f32 v8, v8, v8
v_cvt_pk_bf16_f32 v9, v9, v9
v_cvt_pk_bf16_f32 v10, v10, v10
v_cvt_pk_bf16_f32 v11, v11, v11
v_add_f32_dpp v51, v51, v51 row_ror:1 row_mask:0xf bank_mask:0xf
s_nop 1
v_add_f32_dpp v51, v51, v51 row_ror:2 row_mask:0xf bank_mask:0xf
s_nop 1
v_add_f32_dpp v51, v51, v51 row_ror:4 row_mask:0xf bank_mask:0xf
s_nop 1
v_add_f32_dpp v51, v51, v51 row_ror:8 row_mask:0xf bank_mask:0xf
v_mov_b32 v48, v51
s_nop 1
v_permlane16_swap_b32 v51, v48
v_add_f32 v51, v51, v48
v_mov_b32 v48, v51
s_nop 1
v_permlane32_swap_b32 v51, v48
v_add_f32 v51, v51, v48
s_lshl_b32 s60, s57, 3
s_add_u32 s60, s60, 51744
v_mov_b32 v48, s60
ds_write_b64 v48, v[50:51]
v_and_b32_dpp v40, v8, v4 row_newbcast:0 row_mask:0xf bank_mask:0xf
v_and_b32_dpp v41, v8, v5 row_newbcast:0 row_mask:0xf bank_mask:0xf
v_and_b32_dpp v42, v8, v6 row_newbcast:0 row_mask:0xf bank_mask:0xf
v_and_b32_dpp v43, v8, v7 row_newbcast:0 row_mask:0xf bank_mask:0xf
s_waitcnt vmcnt(5)
buffer_load_dwordx4 v[136:139], v2, s[36:39], s40 offen offset:2048 nt
v_mfma_f32_16x16x32_bf16 v[36:39], v[40:43], v[112:115], 0
v_and_b32_dpp v44, v8, v4 row_newbcast:1 row_mask:0xf bank_mask:0xf
v_and_b32_dpp v45, v8, v5 row_newbcast:1 row_mask:0xf bank_mask:0xf
v_and_b32_dpp v46, v8, v6 row_newbcast:1 row_mask:0xf bank_mask:0xf
v_and_b32_dpp v47, v8, v7 row_newbcast:1 row_mask:0xf bank_mask:0xf
s_waitcnt vmcnt(5)
buffer_load_dwordx4 v[140:143], v2, s[36:39], s40 offen offset:3072 nt
v_mfma_f32_16x16x32_bf16 v[36:39], v[44:47], v[116:119], v[36:39]
v_and_b32_dpp v40, v8, v4 row_newbcast:2 row_mask:0xf bank_mask:0xf
v_and_b32_dpp v41, v8, v5 row_newbcast:2 row_mask:0xf bank_mask:0xf
v_and_b32_dpp v42, v8, v6 row_newbcast:2 row_mask:0xf bank_mask:0xf
v_and_b32_dpp v43, v8, v7 row_newbcast:2 row_mask:0xf bank_mask:0xf
s_waitcnt vmcnt(5)
s_xor_b32 s40, s41, 32768
buffer_load_dwordx4 v[144:147], v2, s[36:39], s40 offen offset:0 nt
v_mfma_f32_16x16x32_bf16 v[36:39], v[40:43], v[120:123], v[36:39]
v_and_b32_dpp v44, v8, v4 row_newbcast:3 row_mask:0xf bank_mask:0xf
v_and_b32_dpp v45, v8, v5 row_newbcast:3 row_mask:0xf bank_mask:0xf
v_and_b32_dpp v46, v8, v6 row_newbcast:3 row_mask:0xf bank_mask:0xf
v_and_b32_dpp v47, v8, v7 row_newbcast:3 row_mask:0xf bank_mask:0xf
s_waitcnt vmcnt(5)
buffer_load_dwordx4 v[148:151], v2, s[36:39], s40 offen offset:1024 nt
v_mfma_f32_16x16x32_bf16 v[36:39], v[44:47], v[124:127], v[36:39]
v_and_b32_dpp v40, v8, v4 row_newbcast:4 row_mask:0xf bank_mask:0xf
v_and_b32_dpp v41, v8, v5 row_newbcast:4 row_mask:0xf bank_mask:0xf
v_and_b32_dpp v42, v8, v6 row_newbcast:4 row_mask:0xf bank_mask:0xf
v_and_b32_dpp v43, v8, v7 row_newbcast:4 row_mask:0xf bank_mask:0xf
s_waitcnt vmcnt(5)
buffer_load_dwordx4 v[152:155], v2, s[36:39], s40 offen offset:2048 nt
v_mfma_f32_16x16x32_bf16 v[36:39], v[40:43], v[128:131], v[36:39]
v_and_b32_dpp v44, v8, v4 row_newbcast:5 row_mask:0xf bank_mask:0xf
v_and_b32_dpp v45, v8, v5 row_newbcast:5 row_mask:0xf bank_mask:0xf
v_and_b32_dpp v46, v8, v6 row_newbcast:5 row_mask:0xf bank_mask:0xf
v_and_b32_dpp v47, v8, v7 row_newbcast:5 row_mask:0xf bank_mask:0xf
s_waitcnt vmcnt(5)
buffer_load_dwordx4 v[156:159], v2, s[36:39], s40 offen offset:3072 nt
v_mfma_f32_16x16x32_bf16 v[36:39], v[44:47], v[132:135], v[36:39]
v_and_b32_dpp v40, v8, v4 row_newbcast:6 row_mask:0xf bank_mask:0xf
v_and_b32_dpp v41, v8, v5 row_newbcast:6 row_mask:0xf bank_mask:0xf
v_and_b32_dpp v42, v8, v6 row_newbcast:6 row_mask:0xf bank_mask:0xf
v_and_b32_dpp v43, v8, v7 row_newbcast:6 row_mask:0xf bank_mask:0xf
s_waitcnt vmcnt(5)
s_xor_b32 s40, s41, 36864
buffer_load_dwordx4 v[160:163], v2, s[36:39], s40 offen offset:0 nt
v_mfma_f32_16x16x32_bf16 v[36:39], v[40:43], v[136:139], v[36:39]
v_and_b32_dpp v44, v8, v4 row_newbcast:7 row_mask:0xf bank_mask:0xf
v_and_b32_dpp v45, v8, v5 row_newbcast:7 row_mask:0xf bank_mask:0xf
v_and_b32_dpp v46, v8, v6 row_newbcast:7 row_mask:0xf bank_mask:0xf
v_and_b32_dpp v47, v8, v7 row_newbcast:7 row_mask:0xf bank_mask:0xf
s_waitcnt vmcnt(5)
buffer_load_dwordx4 v[164:167], v2, s[36:39], s40 offen offset:1024 nt
v_mfma_f32_16x16x32_bf16 v[36:39], v[44:47], v[140:143], v[36:39]
v_and_b32_dpp v40, v8, v4 row_newbcast:8 row_mask:0xf bank_mask:0xf
v_and_b32_dpp v41, v8, v5 row_newbcast:8 row_mask:0xf bank_mask:0xf
v_and_b32_dpp v42, v8, v6 row_newbcast:8 row_mask:0xf bank_mask:0xf
v_and_b32_dpp v43, v8, v7 row_newbcast:8 row_mask:0xf bank_mask:0xf
s_waitcnt vmcnt(5)
buffer_load_dwordx4 v[168:171], v2, s[36:39], s40 offen offset:2048 nt
v_mfma_f32_16x16x32_bf16 v[36:39], v[40:43], v[144:147], v[36:39]
v_and_b32_dpp v44, v8, v4 row_newbcast:9 row_mask:0xf bank_mask:0xf
v_and_b32_dpp v45, v8, v5 row_newbcast:9 row_mask:0xf bank_mask:0xf
v_and_b32_dpp v46, v8, v6 row_newbcast:9 row_mask:0xf bank_mask:0xf
v_and_b32_dpp v47, v8, v7 row_newbcast:9 row_mask:0xf bank_mask:0xf
s_waitcnt vmcnt(5)
buffer_load_dwordx4 v[172:175], v2, s[36:39], s40 offen offset:3072 nt
v_mfma_f32_16x16x32_bf16 v[36:39], v[44:47], v[148:151], v[36:39]
v_and_b32_dpp v40, v8, v4 row_newbcast:10 row_mask:0xf bank_mask:0xf
v_and_b32_dpp v41, v8, v5 row_newbcast:10 row_mask:0xf bank_mask:0xf
v_and_b32_dpp v42, v8, v6 row_newbcast:10 row_mask:0xf bank_mask:0xf
v_and_b32_dpp v43, v8, v7 row_newbcast:10 row_mask:0xf bank_mask:0xf
s_waitcnt vmcnt(5)
s_xor_b32 s40, s41, 65536
buffer_load_dwordx4 v[176:179], v2, s[36:39], s40 offen offset:0 nt
v_mfma_f32_16x16x32_bf16 v[36:39], v[40:43], v[152:155], v[36:39]
v_and_b32_dpp v44, v8, v4 row_newbcast:11 row_mask:0xf bank_mask:0xf
v_and_b32_dpp v45, v8, v5 row_newbcast:11 row_mask:0xf bank_mask:0xf
v_and_b32_dpp v46, v8, v6 row_newbcast:11 row_mask:0xf bank_mask:0xf
v_and_b32_dpp v47, v8, v7 row_newbcast:11 row_mask:0xf bank_mask:0xf
s_waitcnt vmcnt(5)
buffer_load_dwordx4 v[180:183], v2, s[36:39], s40 offen offset:1024 nt
v_mfma_f32_16x16x32_bf16 v[36:39], v[44:47], v[156:159], v[36:39]
v_and_b32_dpp v40, v8, v4 row_newbcast:12 row_mask:0xf bank_mask:0xf
v_and_b32_dpp v41, v8, v5 row_newbcast:12 row_mask:0xf bank_mask:0xf
v_and_b32_dpp v42, v8, v6 row_newbcast:12 row_mask:0xf bank_mask:0xf
v_and_b32_dpp v43, v8, v7 row_newbcast:12 row_mask:0xf bank_mask:0xf
s_waitcnt vmcnt(5)
buffer_load_dwordx4 v[184:187], v2, s[36:39], s40 offen offset:2048 nt
v_mfma_f32_16x16x32_bf16 v[36:39], v[40:43], v[160:163], v[36:39]
v_and_b32_dpp v44, v8, v4 row_newbcast:13 row_mask:0xf bank_mask:0xf
v_and_b32_dpp v45, v8, v5 row_newbcast:13 row_mask:0xf bank_mask:0xf
v_and_b32_dpp v46, v8, v6 row_newbcast:13 row_mask:0xf bank_mask:0xf
v_and_b32_dpp v47, v8, v7 row_newbcast:13 row_mask:0xf bank_mask:0xf
s_waitcnt vmcnt(5)
buffer_load_dwordx4 v[188:191], v2, s[36:39], s40 offen offset:3072 nt
v_mfma_f32_16x16x32_bf16 v[36:39], v[44:47], v[164:167], v[36:39]
v_and_b32_dpp v40, v8, v4 row_newbcast:14 row_mask:0xf bank_mask:0xf
v_and_b32_dpp v41, v8, v5 row_newbcast:14 row_mask:0xf bank_mask:0xf
v_and_b32_dpp v42, v8, v6 row_newbcast:14 row_mask:0xf bank_mask:0xf
v_and_b32_dpp v43, v8, v7 row_newbcast:14 row_mask:0xf bank_mask:0xf
s_waitcnt vmcnt(5)
s_xor_b32 s40, s41, 69632
buffer_load_dwordx4 v[192:195], v2, s[36:39], s40 offen offset:0 nt
v_mfma_f32_16x16x32_bf16 v[36:39], v[40:43], v[168:171], v[36:39]
v_and_b32_dpp v44, v8, v4 row_newbcast:15 row_mask:0xf bank_mask:0xf
v_and_b32_dpp v45, v8, v5 row_newbcast:15 row_mask:0xf bank_mask:0xf
v_and_b32_dpp v46, v8, v6 row_newbcast:15 row_mask:0xf bank_mask:0xf
v_and_b32_dpp v47, v8, v7 row_newbcast:15 row_mask:0xf bank_mask:0xf
s_waitcnt vmcnt(5)
buffer_load_dwordx4 v[196:199], v2, s[36:39], s40 offen offset:1024 nt
v_mfma_f32_16x16x32_bf16 v[36:39], v[44:47], v[172:175], v[36:39]
v_and_b32_dpp v40, v9, v4 row_newbcast:0 row_mask:0xf bank_mask:0xf
v_and_b32_dpp v41, v9, v5 row_newbcast:0 row_mask:0xf bank_mask:0xf
v_and_b32_dpp v42, v9, v6 row_newbcast:0 row_mask:0xf bank_mask:0xf
v_and_b32_dpp v43, v9, v7 row_newbcast:0 row_mask:0xf bank_mask:0xf
s_waitcnt vmcnt(5)
buffer_load_dwordx4 v[200:203], v2, s[36:39], s40 offen offset:2048 nt
v_mfma_f32_16x16x32_bf16 v[36:39], v[40:43], v[176:179], v[36:39]
v_and_b32_dpp v44, v9, v4 row_newbcast:1 row_mask:0xf bank_mask:0xf
v_and_b32_dpp v45, v9, v5 row_newbcast:1 row_mask:0xf bank_mask:0xf
v_and_b32_dpp v46, v9, v6 row_newbcast:1 row_mask:0xf bank_mask:0xf
v_and_b32_dpp v47, v9, v7 row_newbcast:1 row_mask:0xf bank_mask:0xf
s_waitcnt vmcnt(5)
buffer_load_dwordx4 v[204:207], v2, s[36:39], s40 offen offset:3072 nt
v_mfma_f32_16x16x32_bf16 v[36:39], v[44:47], v[180:183], v[36:39]
v_and_b32_dpp v40, v9, v4 row_newbcast:2 row_mask:0xf bank_mask:0xf
v_and_b32_dpp v41, v9, v5 row_newbcast:2 row_mask:0xf bank_mask:0xf
v_and_b32_dpp v42, v9, v6 row_newbcast:2 row_mask:0xf bank_mask:0xf
v_and_b32_dpp v43, v9, v7 row_newbcast:2 row_mask:0xf bank_mask:0xf
s_waitcnt vmcnt(5)
s_xor_b32 s40, s41, 98304
buffer_load_dwordx4 v[208:211], v2, s[36:39], s40 offen offset:0 nt
v_mfma_f32_16x16x32_bf16 v[36:39], v[40:43], v[184:187], v[36:39]
v_and_b32_dpp v44, v9, v4 row_newbcast:3 row_mask:0xf bank_mask:0xf
v_and_b32_dpp v45, v9, v5 row_newbcast:3 row_mask:0xf bank_mask:0xf
v_and_b32_dpp v46, v9, v6 row_newbcast:3 row_mask:0xf bank_mask:0xf
v_and_b32_dpp v47, v9, v7 row_newbcast:3 row_mask:0xf bank_mask:0xf
s_waitcnt vmcnt(5)
buffer_load_dwordx4 v[212:215], v2, s[36:39], s40 offen offset:1024 nt
v_mfma_f32_16x16x32_bf16 v[36:39], v[44:47], v[188:191], v[36:39]
v_and_b32_dpp v40, v9, v4 row_newbcast:4 row_mask:0xf bank_mask:0xf
v_and_b32_dpp v41, v9, v5 row_newbcast:4 row_mask:0xf bank_mask:0xf
v_and_b32_dpp v42, v9, v6 row_newbcast:4 row_mask:0xf bank_mask:0xf
v_and_b32_dpp v43, v9, v7 row_newbcast:4 row_mask:0xf bank_mask:0xf
s_waitcnt vmcnt(5)
buffer_load_dwordx4 v[216:219], v2, s[36:39], s40 offen offset:2048 nt
v_mfma_f32_16x16x32_bf16 v[36:39], v[40:43], v[192:195], v[36:39]
v_and_b32_dpp v44, v9, v4 row_newbcast:5 row_mask:0xf bank_mask:0xf
v_and_b32_dpp v45, v9, v5 row_newbcast:5 row_mask:0xf bank_mask:0xf
v_and_b32_dpp v46, v9, v6 row_newbcast:5 row_mask:0xf bank_mask:0xf
v_and_b32_dpp v47, v9, v7 row_newbcast:5 row_mask:0xf bank_mask:0xf
s_waitcnt vmcnt(5)
buffer_load_dwordx4 v[220:223], v2, s[36:39], s40 offen offset:3072 nt
v_mfma_f32_16x16x32_bf16 v[36:39], v[44:47], v[196:199], v[36:39]
v_and_b32_dpp v40, v9, v4 row_newbcast:6 row_mask:0xf bank_mask:0xf
v_and_b32_dpp v41, v9, v5 row_newbcast:6 row_mask:0xf bank_mask:0xf
v_and_b32_dpp v42, v9, v6 row_newbcast:6 row_mask:0xf bank_mask:0xf
v_and_b32_dpp v43, v9, v7 row_newbcast:6 row_mask:0xf bank_mask:0xf
s_waitcnt vmcnt(5)
s_xor_b32 s40, s41, 102400
buffer_load_dwordx4 v[224:227], v2, s[36:39], s40 offen offset:0 nt
v_mfma_f32_16x16x32_bf16 v[36:39], v[40:43], v[200:203], v[36:39]
v_and_b32_dpp v44, v9, v4 row_newbcast:7 row_mask:0xf bank_mask:0xf
v_and_b32_dpp v45, v9, v5 row_newbcast:7 row_mask:0xf bank_mask:0xf
v_and_b32_dpp v46, v9, v6 row_newbcast:7 row_mask:0xf bank_mask:0xf
v_and_b32_dpp v47, v9, v7 row_newbcast:7 row_mask:0xf bank_mask:0xf
s_waitcnt vmcnt(5)
buffer_load_dwordx4 v[228:231], v2, s[36:39], s40 offen offset:1024 nt
v_mfma_f32_16x16x32_bf16 v[36:39], v[44:47], v[204:207], v[36:39]
v_and_b32_dpp v40, v9, v4 row_newbcast:8 row_mask:0xf bank_mask:0xf
v_and_b32_dpp v41, v9, v5 row_newbcast:8 row_mask:0xf bank_mask:0xf
v_and_b32_dpp v42, v9, v6 row_newbcast:8 row_mask:0xf bank_mask:0xf
v_and_b32_dpp v43, v9, v7 row_newbcast:8 row_mask:0xf bank_mask:0xf
s_waitcnt vmcnt(5)
buffer_load_dwordx4 v[232:235], v2, s[36:39], s40 offen offset:2048 nt
v_mfma_f32_16x16x32_bf16 v[36:39], v[40:43], v[208:211], v[36:39]
v_and_b32_dpp v44, v9, v4 row_newbcast:9 row_mask:0xf bank_mask:0xf
v_and_b32_dpp v45, v9, v5 row_newbcast:9 row_mask:0xf bank_mask:0xf
v_and_b32_dpp v46, v9, v6 row_newbcast:9 row_mask:0xf bank_mask:0xf
v_and_b32_dpp v47, v9, v7 row_newbcast:9 row_mask:0xf bank_mask:0xf
s_waitcnt vmcnt(5)
buffer_load_dwordx4 v[236:239], v2, s[36:39], s40 offen offset:3072 nt
v_mfma_f32_16x16x32_bf16 v[36:39], v[44:47], v[212:215], v[36:39]
v_and_b32_dpp v40, v9, v4 row_newbcast:10 row_mask:0xf bank_mask:0xf
v_and_b32_dpp v41, v9, v5 row_newbcast:10 row_mask:0xf bank_mask:0xf
v_and_b32_dpp v42, v9, v6 row_newbcast:10 row_mask:0xf bank_mask:0xf
v_and_b32_dpp v43, v9, v7 row_newbcast:10 row_mask:0xf bank_mask:0xf
s_waitcnt vmcnt(5)
s_xor_b32 s40, s41, 131072
buffer_load_dwordx4 v[240:243], v2, s[36:39], s40 offen offset:0 nt
v_mfma_f32_16x16x32_bf16 v[36:39], v[40:43], v[216:219], v[36:39]
v_and_b32_dpp v44, v9, v4 row_newbcast:11 row_mask:0xf bank_mask:0xf
v_and_b32_dpp v45, v9, v5 row_newbcast:11 row_mask:0xf bank_mask:0xf
v_and_b32_dpp v46, v9, v6 row_newbcast:11 row_mask:0xf bank_mask:0xf
v_and_b32_dpp v47, v9, v7 row_newbcast:11 row_mask:0xf bank_mask:0xf
s_waitcnt vmcnt(5)
buffer_load_dwordx4 v[244:247], v2, s[36:39], s40 offen offset:1024 nt
v_mfma_f32_16x16x32_bf16 v[36:39], v[44:47], v[220:223], v[36:39]
v_and_b32_dpp v40, v9, v4 row_newbcast:12 row_mask:0xf bank_mask:0xf
v_and_b32_dpp v41, v9, v5 row_newbcast:12 row_mask:0xf bank_mask:0xf
v_and_b32_dpp v42, v9, v6 row_newbcast:12 row_mask:0xf bank_mask:0xf
v_and_b32_dpp v43, v9, v7 row_newbcast:12 row_mask:0xf bank_mask:0xf
s_waitcnt vmcnt(5)
buffer_load_dwordx4 v[248:251], v2, s[36:39], s40 offen offset:2048 nt
v_mfma_f32_16x16x32_bf16 v[36:39], v[40:43], v[224:227], v[36:39]
v_and_b32_dpp v44, v9, v4 row_newbcast:13 row_mask:0xf bank_mask:0xf
v_and_b32_dpp v45, v9, v5 row_newbcast:13 row_mask:0xf bank_mask:0xf
v_and_b32_dpp v46, v9, v6 row_newbcast:13 row_mask:0xf bank_mask:0xf
v_and_b32_dpp v47, v9, v7 row_newbcast:13 row_mask:0xf bank_mask:0xf
s_waitcnt vmcnt(5)
buffer_load_dwordx4 v[252:255], v2, s[36:39], s40 offen offset:3072 nt
v_mfma_f32_16x16x32_bf16 v[36:39], v[44:47], v[228:231], v[36:39]
v_and_b32_dpp v40, v9, v4 row_newbcast:14 row_mask:0xf bank_mask:0xf
v_and_b32_dpp v41, v9, v5 row_newbcast:14 row_mask:0xf bank_mask:0xf
v_and_b32_dpp v42, v9, v6 row_newbcast:14 row_mask:0xf bank_mask:0xf
v_and_b32_dpp v43, v9, v7 row_newbcast:14 row_mask:0xf bank_mask:0xf
s_waitcnt vmcnt(5)
s_xor_b32 s40, s41, 135168
buffer_load_dwordx4 v[56:59], v2, s[36:39], s40 offen offset:0 nt
v_mfma_f32_16x16x32_bf16 v[36:39], v[40:43], v[232:235], v[36:39]
v_and_b32_dpp v44, v9, v4 row_newbcast:15 row_mask:0xf bank_mask:0xf
v_and_b32_dpp v45, v9, v5 row_newbcast:15 row_mask:0xf bank_mask:0xf
v_and_b32_dpp v46, v9, v6 row_newbcast:15 row_mask:0xf bank_mask:0xf
v_and_b32_dpp v47, v9, v7 row_newbcast:15 row_mask:0xf bank_mask:0xf
s_waitcnt vmcnt(5)
buffer_load_dwordx4 v[60:63], v2, s[36:39], s40 offen offset:1024 nt
v_mfma_f32_16x16x32_bf16 v[36:39], v[44:47], v[236:239], v[36:39]
v_and_b32_dpp v40, v10, v4 row_newbcast:0 row_mask:0xf bank_mask:0xf
v_and_b32_dpp v41, v10, v5 row_newbcast:0 row_mask:0xf bank_mask:0xf
v_and_b32_dpp v42, v10, v6 row_newbcast:0 row_mask:0xf bank_mask:0xf
v_and_b32_dpp v43, v10, v7 row_newbcast:0 row_mask:0xf bank_mask:0xf
s_waitcnt vmcnt(5)
buffer_load_dwordx4 v[64:67], v2, s[36:39], s40 offen offset:2048 nt
v_mfma_f32_16x16x32_bf16 v[36:39], v[40:43], v[240:243], v[36:39]
v_and_b32_dpp v44, v10, v4 row_newbcast:1 row_mask:0xf bank_mask:0xf
v_and_b32_dpp v45, v10, v5 row_newbcast:1 row_mask:0xf bank_mask:0xf
v_and_b32_dpp v46, v10, v6 row_newbcast:1 row_mask:0xf bank_mask:0xf
v_and_b32_dpp v47, v10, v7 row_newbcast:1 row_mask:0xf bank_mask:0xf
s_waitcnt vmcnt(5)
buffer_load_dwordx4 v[68:71], v2, s[36:39], s40 offen offset:3072 nt
v_mfma_f32_16x16x32_bf16 v[36:39], v[44:47], v[244:247], v[36:39]
v_and_b32_dpp v40, v10, v4 row_newbcast:2 row_mask:0xf bank_mask:0xf
v_and_b32_dpp v41, v10, v5 row_newbcast:2 row_mask:0xf bank_mask:0xf
v_and_b32_dpp v42, v10, v6 row_newbcast:2 row_mask:0xf bank_mask:0xf
v_and_b32_dpp v43, v10, v7 row_newbcast:2 row_mask:0xf bank_mask:0xf
s_waitcnt vmcnt(5)
s_xor_b32 s40, s41, 163840
buffer_load_dwordx4 v[72:75], v2, s[36:39], s40 offen offset:0 nt
v_mfma_f32_16x16x32_bf16 v[36:39], v[40:43], v[248:251], v[36:39]
v_and_b32_dpp v44, v10, v4 row_newbcast:3 row_mask:0xf bank_mask:0xf
v_and_b32_dpp v45, v10, v5 row_newbcast:3 row_mask:0xf bank_mask:0xf
v_and_b32_dpp v46, v10, v6 row_newbcast:3 row_mask:0xf bank_mask:0xf
v_and_b32_dpp v47, v10, v7 row_newbcast:3 row_mask:0xf bank_mask:0xf
s_waitcnt vmcnt(5)
buffer_load_dwordx4 v[76:79], v2, s[36:39], s40 offen offset:1024 nt
v_mfma_f32_16x16x32_bf16 v[36:39], v[44:47], v[252:255], v[36:39]
v_and_b32_dpp v40, v10, v4 row_newbcast:4 row_mask:0xf bank_mask:0xf
v_and_b32_dpp v41, v10, v5 row_newbcast:4 row_mask:0xf bank_mask:0xf
v_and_b32_dpp v42, v10, v6 row_newbcast:4 row_mask:0xf bank_mask:0xf
v_and_b32_dpp v43, v10, v7 row_newbcast:4 row_mask:0xf bank_mask:0xf
s_waitcnt vmcnt(5)
buffer_load_dwordx4 v[80:83], v2, s[36:39], s40 offen offset:2048 nt
v_mfma_f32_16x16x32_bf16 v[36:39], v[40:43], v[56:59], v[36:39]
v_and_b32_dpp v44, v10, v4 row_newbcast:5 row_mask:0xf bank_mask:0xf
v_and_b32_dpp v45, v10, v5 row_newbcast:5 row_mask:0xf bank_mask:0xf
v_and_b32_dpp v46, v10, v6 row_newbcast:5 row_mask:0xf bank_mask:0xf
v_and_b32_dpp v47, v10, v7 row_newbcast:5 row_mask:0xf bank_mask:0xf
s_waitcnt vmcnt(5)
buffer_load_dwordx4 v[84:87], v2, s[36:39], s40 offen offset:3072 nt
v_mfma_f32_16x16x32_bf16 v[36:39], v[44:47], v[60:63], v[36:39]
v_and_b32_dpp v40, v10, v4 row_newbcast:6 row_mask:0xf bank_mask:0xf
v_and_b32_dpp v41, v10, v5 row_newbcast:6 row_mask:0xf bank_mask:0xf
v_and_b32_dpp v42, v10, v6 row_newbcast:6 row_mask:0xf bank_mask:0xf
v_and_b32_dpp v43, v10, v7 row_newbcast:6 row_mask:0xf bank_mask:0xf
s_waitcnt vmcnt(5)
s_xor_b32 s40, s41, 167936
buffer_load_dwordx4 v[88:91], v2, s[36:39], s40 offen offset:0 nt
v_mfma_f32_16x16x32_bf16 v[36:39], v[40:43], v[64:67], v[36:39]
v_and_b32_dpp v44, v10, v4 row_newbcast:7 row_mask:0xf bank_mask:0xf
v_and_b32_dpp v45, v10, v5 row_newbcast:7 row_mask:0xf bank_mask:0xf
v_and_b32_dpp v46, v10, v6 row_newbcast:7 row_mask:0xf bank_mask:0xf
v_and_b32_dpp v47, v10, v7 row_newbcast:7 row_mask:0xf bank_mask:0xf
s_waitcnt vmcnt(5)
buffer_load_dwordx4 v[92:95], v2, s[36:39], s40 offen offset:1024 nt
v_mfma_f32_16x16x32_bf16 v[36:39], v[44:47], v[68:71], v[36:39]
v_and_b32_dpp v40, v10, v4 row_newbcast:8 row_mask:0xf bank_mask:0xf
v_and_b32_dpp v41, v10, v5 row_newbcast:8 row_mask:0xf bank_mask:0xf
v_and_b32_dpp v42, v10, v6 row_newbcast:8 row_mask:0xf bank_mask:0xf
v_and_b32_dpp v43, v10, v7 row_newbcast:8 row_mask:0xf bank_mask:0xf
s_waitcnt vmcnt(5)
buffer_load_dwordx4 v[96:99], v2, s[36:39], s40 offen offset:2048 nt
v_mfma_f32_16x16x32_bf16 v[36:39], v[40:43], v[72:75], v[36:39]
v_and_b32_dpp v44, v10, v4 row_newbcast:9 row_mask:0xf bank_mask:0xf
v_and_b32_dpp v45, v10, v5 row_newbcast:9 row_mask:0xf bank_mask:0xf
v_and_b32_dpp v46, v10, v6 row_newbcast:9 row_mask:0xf bank_mask:0xf
v_and_b32_dpp v47, v10, v7 row_newbcast:9 row_mask:0xf bank_mask:0xf
v_mov_b32 v48, 51744
s_mov_b32 s98, 0
L_stat:
ds_read_b128 v[12:15], v48
ds_read_b128 v[16:19], v48 offset:16
s_waitcnt lgkmcnt(0)
v_min_u32 v20, v13, v15
v_min3_u32 v20, v20, v17, v19
v_cmp_eq_u32 vcc, 0, v20
s_nop 4
s_cbranch_vccz L_stat_ok
s_add_u32 s98, s98, 1
s_cmp_lt_u32 s98, 4194304
s_cbranch_scc1 L_stat
L_stat_ok:
v_max3_f32 v20, v12, v14, v16
v_max_f32 v20, v20, v18
v_sub_f32 v12, v12, v20
v_sub_f32 v14, v14, v20
v_sub_f32 v16, v16, v20
v_sub_f32 v18, v18, v20
v_sub_f32 v50, v50, v20
v_mul_f32 v12, s59, v12
v_mul_f32 v14, s59, v14
v_mul_f32 v16, s59, v16
v_mul_f32 v18, s59, v18
v_mul_f32 v50, s59, v50
v_exp_f32 v12, v12
v_exp_f32 v14, v14
v_exp_f32 v16, v16
v_exp_f32 v18, v18
v_exp_f32 v50, v50
v_mul_f32 v21, v12, v13
v_fmac_f32 v21, v14, v15
v_fmac_f32 v21, v16, v17
v_fmac_f32 v21, v18, v19
v_rcp_f32 v21, v21
s_nop 0
v_mul_f32 v50, v50, v21
v_and_b32 v49, 15, v0
v_lshlrev_b32 v49, 5, v49
v_lshrrev_b32 v48, 4, v0
v_lshl_add_u32 v49, v48, 4, v49
s_lshl_b32 s60, s57, 9
s_add_u32 s60, s60, 52224
v_add_u32 v49, s60, v49
s_waitcnt vmcnt(5)
buffer_load_dwordx4 v[100:103], v2, s[36:39], s40 offen offset:3072 nt
v_mfma_f32_16x16x32_bf16 v[36:39], v[44:47], v[76:79], v[36:39]
v_and_b32_dpp v40, v10, v4 row_newbcast:10 row_mask:0xf bank_mask:0xf
v_and_b32_dpp v41, v10, v5 row_newbcast:10 row_mask:0xf bank_mask:0xf
v_and_b32_dpp v42, v10, v6 row_newbcast:10 row_mask:0xf bank_mask:0xf
v_and_b32_dpp v43, v10, v7 row_newbcast:10 row_mask:0xf bank_mask:0xf
s_waitcnt vmcnt(9)
s_xor_b32 s40, s41, 196608
buffer_load_dwordx4 v[104:107], v2, s[36:39], s40 offen offset:0 nt
s_waitcnt vmcnt(9)
buffer_load_dwordx4 v[108:111], v2, s[36:39], s40 offen offset:1024 nt
s_waitcnt vmcnt(9)
buffer_load_dwordx4 v[112:115], v2, s[36:39], s40 offen offset:2048 nt
s_waitcnt vmcnt(9)
buffer_load_dwordx4 v[116:119], v2, s[36:39], s40 offen offset:3072 nt
s_waitcnt vmcnt(9)
s_xor_b32 s40, s41, 200704
buffer_load_dwordx4 v[120:123], v2, s[36:39], s40 offen offset:0 nt
v_mfma_f32_16x16x32_bf16 v[36:39], v[40:43], v[80:83], v[36:39]
v_and_b32_dpp v44, v10, v4 row_newbcast:11 row_mask:0xf bank_mask:0xf
v_and_b32_dpp v45, v10, v5 row_newbcast:11 row_mask:0xf bank_mask:0xf
v_and_b32_dpp v46, v10, v6 row_newbcast:11 row_mask:0xf bank_mask:0xf
v_and_b32_dpp v47, v10, v7 row_newbcast:11 row_mask:0xf bank_mask:0xf
s_waitcnt vmcnt(9)
buffer_load_dwordx4 v[124:127], v2, s[36:39], s40 offen offset:1024 nt
v_mfma_f32_16x16x32_bf16 v[36:39], v[44:47], v[84:87], v[36:39]
v_and_b32_dpp v40, v10, v4 row_newbcast:12 row_mask:0xf bank_mask:0xf
v_and_b32_dpp v41, v10, v5 row_newbcast:12 row_mask:0xf bank_mask:0xf
v_and_b32_dpp v42, v10, v6 row_newbcast:12 row_mask:0xf bank_mask:0xf
v_and_b32_dpp v43, v10, v7 row_newbcast:12 row_mask:0xf bank_mask:0xf
s_waitcnt vmcnt(9)
buffer_load_dwordx4 v[128:131], v2, s[36:39], s40 offen offset:2048 nt
v_mfma_f32_16x16x32_bf16 v[36:39], v[40:43], v[88:91], v[36:39]
v_and_b32_dpp v44, v10, v4 row_newbcast:13 row_mask:0xf bank_mask:0xf
v_and_b32_dpp v45, v10, v5 row_newbcast:13 row_mask:0xf bank_mask:0xf
v_and_b32_dpp v46, v10, v6 row_newbcast:13 row_mask:0xf bank_mask:0xf
v_and_b32_dpp v47, v10, v7 row_newbcast:13 row_mask:0xf bank_mask:0xf
s_waitcnt vmcnt(9)
buffer_load_dwordx4 v[132:135], v2, s[36:39], s40 offen offset:3072 nt
v_mfma_f32_16x16x32_bf16 v[36:39], v[44:47], v[92:95], v[36:39]
v_and_b32_dpp v40, v10, v4 row_newbcast:14 row_mask:0xf bank_mask:0xf
v_and_b32_dpp v41, v10, v5 row_newbcast:14 row_mask:0xf bank_mask:0xf
v_and_b32_dpp v42, v10, v6 row_newbcast:14 row_mask:0xf bank_mask:0xf
v_and_b32_dpp v43, v10, v7 row_newbcast:14 row_mask:0xf bank_mask:0xf
s_waitcnt vmcnt(9)
s_xor_b32 s40, s41, 229376
buffer_load_dwordx4 v[136:139], v2, s[36:39], s40 offen offset:0 nt
v_mfma_f32_16x16x32_bf16 v[36:39], v[40:43], v[96:99], v[36:39]
v_and_b32_dpp v44, v10, v4 row_newbcast:15 row_mask:0xf bank_mask:0xf
v_and_b32_dpp v45, v10, v5 row_newbcast:15 row_mask:0xf bank_mask:0xf
v_and_b32_dpp v46, v10, v6 row_newbcast:15 row_mask:0xf bank_mask:0xf
v_and_b32_dpp v47, v10, v7 row_newbcast:15 row_mask:0xf bank_mask:0xf
s_waitcnt vmcnt(9)
buffer_load_dwordx4 v[140:143], v2, s[36:39], s40 offen offset:1024 nt
v_mfma_f32_16x16x32_bf16 v[36:39], v[44:47], v[100:103], v[36:39]
v_and_b32_dpp v40, v11, v4 row_newbcast:0 row_mask:0xf bank_mask:0xf
v_and_b32_dpp v41, v11, v5 row_newbcast:0 row_mask:0xf bank_mask:0xf
v_and_b32_dpp v42, v11, v6 row_newbcast:0 row_mask:0xf bank_mask:0xf
v_and_b32_dpp v43, v11, v7 row_newbcast:0 row_mask:0xf bank_mask:0xf
s_waitcnt vmcnt(9)
buffer_load_dwordx4 v[144:147], v2, s[36:39], s40 offen offset:2048 nt
v_mfma_f32_16x16x32_bf16 v[36:39], v[40:43], v[104:107], v[36:39]
v_and_b32_dpp v44, v11, v4 row_newbcast:1 row_mask:0xf bank_mask:0xf
v_and_b32_dpp v45, v11, v5 row_newbcast:1 row_mask:0xf bank_mask:0xf
v_and_b32_dpp v46, v11, v6 row_newbcast:1 row_mask:0xf bank_mask:0xf
v_and_b32_dpp v47, v11, v7 row_newbcast:1 row_mask:0xf bank_mask:0xf
s_waitcnt vmcnt(9)
buffer_load_dwordx4 v[148:151], v2, s[36:39], s40 offen offset:3072 nt
v_mfma_f32_16x16x32_bf16 v[36:39], v[44:47], v[108:111], v[36:39]
v_and_b32_dpp v40, v11, v4 row_newbcast:2 row_mask:0xf bank_mask:0xf
v_and_b32_dpp v41, v11, v5 row_newbcast:2 row_mask:0xf bank_mask:0xf
v_and_b32_dpp v42, v11, v6 row_newbcast:2 row_mask:0xf bank_mask:0xf
v_and_b32_dpp v43, v11, v7 row_newbcast:2 row_mask:0xf bank_mask:0xf
s_waitcnt vmcnt(9)
s_xor_b32 s40, s41, 233472
buffer_load_dwordx4 v[152:155], v2, s[36:39], s40 offen offset:0 nt
v_mfma_f32_16x16x32_bf16 v[36:39], v[40:43], v[112:115], v[36:39]
v_and_b32_dpp v44, v11, v4 row_newbcast:3 row_mask:0xf bank_mask:0xf
v_and_b32_dpp v45, v11, v5 row_newbcast:3 row_mask:0xf bank_mask:0xf
v_and_b32_dpp v46, v11, v6 row_newbcast:3 row_mask:0xf bank_mask:0xf
v_and_b32_dpp v47, v11, v7 row_newbcast:3 row_mask:0xf bank_mask:0xf
s_waitcnt vmcnt(9)
buffer_load_dwordx4 v[156:159], v2, s[36:39], s40 offen offset:1024 nt
v_mfma_f32_16x16x32_bf16 v[36:39], v[44:47], v[116:119], v[36:39]
v_and_b32_dpp v40, v11, v4 row_newbcast:4 row_mask:0xf bank_mask:0xf
v_and_b32_dpp v41, v11, v5 row_newbcast:4 row_mask:0xf bank_mask:0xf
v_and_b32_dpp v42, v11, v6 row_newbcast:4 row_mask:0xf bank_mask:0xf
v_and_b32_dpp v43, v11, v7 row_newbcast:4 row_mask:0xf bank_mask:0xf
s_waitcnt vmcnt(9)
buffer_load_dwordx4 v[160:163], v2, s[36:39], s40 offen offset:2048 nt
v_mfma_f32_16x16x32_bf16 v[36:39], v[40:43], v[120:123], v[36:39]
v_and_b32_dpp v44, v11, v4 row_newbcast:5 row_mask:0xf bank_mask:0xf
v_and_b32_dpp v45, v11, v5 row_newbcast:5 row_mask:0xf bank_mask:0xf
v_and_b32_dpp v46, v11, v6 row_newbcast:5 row_mask:0xf bank_mask:0xf
v_and_b32_dpp v47, v11, v7 row_newbcast:5 row_mask:0xf bank_mask:0xf
s_waitcnt vmcnt(9)
buffer_load_dwordx4 v[164:167], v2, s[36:39], s40 offen offset:3072 nt
v_and_b32_dpp v168, v11, v4 row_newbcast:6 row_mask:0xf bank_mask:0xf
v_and_b32_dpp v169, v11, v5 row_newbcast:6 row_mask:0xf bank_mask:0xf
v_and_b32_dpp v170, v11, v6 row_newbcast:6 row_mask:0xf bank_mask:0xf
v_and_b32_dpp v171, v11, v7 row_newbcast:6 row_mask:0xf bank_mask:0xf
v_and_b32_dpp v172, v11, v4 row_newbcast:7 row_mask:0xf bank_mask:0xf
v_and_b32_dpp v173, v11, v5 row_newbcast:7 row_mask:0xf bank_mask:0xf
v_and_b32_dpp v174, v11, v6 row_newbcast:7 row_mask:0xf bank_mask:0xf
v_and_b32_dpp v175, v11, v7 row_newbcast:7 row_mask:0xf bank_mask:0xf
v_and_b32_dpp v176, v11, v4 row_newbcast:8 row_mask:0xf bank_mask:0xf
v_and_b32_dpp v177, v11, v5 row_newbcast:8 row_mask:0xf bank_mask:0xf
v_and_b32_dpp v178, v11, v6 row_newbcast:8 row_mask:0xf bank_mask:0xf
v_and_b32_dpp v179, v11, v7 row_newbcast:8 row_mask:0xf bank_mask:0xf
v_and_b32_dpp v180, v11, v4 row_newbcast:9 row_mask:0xf bank_mask:0xf
v_and_b32_dpp v181, v11, v5 row_newbcast:9 row_mask:0xf bank_mask:0xf
v_and_b32_dpp v182, v11, v6 row_newbcast:9 row_mask:0xf bank_mask:0xf
v_and_b32_dpp v183, v11, v7 row_newbcast:9 row_mask:0xf bank_mask:0xf
v_and_b32_dpp v184, v11, v4 row_newbcast:10 row_mask:0xf bank_mask:0xf
v_and_b32_dpp v185, v11, v5 row_newbcast:10 row_mask:0xf bank_mask:0xf
v_and_b32_dpp v186, v11, v6 row_newbcast:10 row_mask:0xf bank_mask:0xf
v_and_b32_dpp v187, v11, v7 row_newbcast:10 row_mask:0xf bank_mask:0xf
v_and_b32_dpp v188, v11, v4 row_newbcast:11 row_mask:0xf bank_mask:0xf
v_and_b32_dpp v189, v11, v5 row_newbcast:11 row_mask:0xf bank_mask:0xf
v_and_b32_dpp v190, v11, v6 row_newbcast:11 row_mask:0xf bank_mask:0xf
v_and_b32_dpp v191, v11, v7 row_newbcast:11 row_mask:0xf bank_mask:0xf
v_and_b32_dpp v192, v11, v4 row_newbcast:12 row_mask:0xf bank_mask:0xf
v_and_b32_dpp v193, v11, v5 row_newbcast:12 row_mask:0xf bank_mask:0xf
v_and_b32_dpp v194, v11, v6 row_newbcast:12 row_mask:0xf bank_mask:0xf
v_and_b32_dpp v195, v11, v7 row_newbcast:12 row_mask:0xf bank_mask:0xf
v_and_b32_dpp v196, v11, v4 row_newbcast:13 row_mask:0xf bank_mask:0xf
v_and_b32_dpp v197, v11, v5 row_newbcast:13 row_mask:0xf bank_mask:0xf
v_and_b32_dpp v198, v11, v6 row_newbcast:13 row_mask:0xf bank_mask:0xf
v_and_b32_dpp v199, v11, v7 row_newbcast:13 row_mask:0xf bank_mask:0xf
v_and_b32_dpp v200, v11, v4 row_newbcast:14 row_mask:0xf bank_mask:0xf
v_and_b32_dpp v201, v11, v5 row_newbcast:14 row_mask:0xf bank_mask:0xf
v_and_b32_dpp v202, v11, v6 row_newbcast:14 row_mask:0xf bank_mask:0xf
v_and_b32_dpp v203, v11, v7 row_newbcast:14 row_mask:0xf bank_mask:0xf
v_and_b32_dpp v204, v11, v4 row_newbcast:15 row_mask:0xf bank_mask:0xf
v_and_b32_dpp v205, v11, v5 row_newbcast:15 row_mask:0xf bank_mask:0xf
v_and_b32_dpp v206, v11, v6 row_newbcast:15 row_mask:0xf bank_mask:0xf
v_and_b32_dpp v207, v11, v7 row_newbcast:15 row_mask:0xf bank_mask:0xf
v_mfma_f32_16x16x32_bf16 v[36:39], v[44:47], v[124:127], v[36:39]
s_waitcnt vmcnt(9)
v_mfma_f32_16x16x32_bf16 v[36:39], v[168:171], v[128:131], v[36:39]
s_waitcnt vmcnt(8)
v_mfma_f32_16x16x32_bf16 v[36:39], v[172:175], v[132:135], v[36:39]
s_waitcnt vmcnt(7)
v_mfma_f32_16x16x32_bf16 v[36:39], v[176:179], v[136:139], v[36:39]
s_waitcnt vmcnt(6)
v_mfma_f32_16x16x32_bf16 v[36:39], v[180:183], v[140:143], v[36:39]
s_waitcnt vmcnt(5)
v_mfma_f32_16x16x32_bf16 v[36:39], v[184:187], v[144:147], v[36:39]
s_waitcnt vmcnt(4)
v_mfma_f32_16x16x32_bf16 v[36:39], v[188:191], v[148:151], v[36:39]
s_waitcnt vmcnt(3)
v_mfma_f32_16x16x32_bf16 v[36:39], v[192:195], v[152:155], v[36:39]
s_waitcnt vmcnt(2)
v_mfma_f32_16x16x32_bf16 v[36:39], v[196:199], v[156:159], v[36:39]
s_waitcnt vmcnt(1)
v_mfma_f32_16x16x32_bf16 v[36:39], v[200:203], v[160:163], v[36:39]
s_waitcnt vmcnt(0)
v_mfma_f32_16x16x32_bf16 v[36:39], v[204:207], v[164:167], v[36:39]
s_nop 7
v_mul_f32 v36, v36, v50
v_mul_f32 v37, v37, v50
v_mul_f32 v38, v38, v50
v_mul_f32 v39, v39, v50
s_mov_b32 exec_hi, 0
ds_write_b128 v49, v[36:39]
s_waitcnt lgkmcnt(0)
s_barrier
s_endpgm
.section .rodata,"a"
.p2align 6
.amdhsa_kernel gated_mix__sliding_block_cached__glu_gated_swiglu__decode_kernel
  .amdhsa_next_free_vgpr 256
  .amdhsa_next_free_sgpr 102
  .amdhsa_accum_offset 256
  .amdhsa_group_segment_fixed_size 0
  .amdhsa_kernarg_size 104
  .amdhsa_user_sgpr_count 2
  .amdhsa_user_sgpr_kernarg_segment_ptr 1
  .amdhsa_system_sgpr_workgroup_id_x 1
  .amdhsa_float_denorm_mode_32 3
.end_amdhsa_kernel
```
